```python
import torch

def _softmax(x, axis=-1):
    return torch.softmax(x, dim=axis)
def _gelu(x):
    return torch.nn.functional.gelu(x, approximate="tanh")
def _silu(x):
    return torch.nn.functional.silu(x)
def _sigmoid(x):
    return torch.sigmoid(x)
def _layernorm(x, axis=-1, eps=1e-5):
    m = x.mean(dim=axis, keepdim=True)
    v = x.var(dim=axis, keepdim=True, unbiased=False)
    return (x - m) / torch.sqrt(v + eps)
def _scatter_add(tgt, idx, src, axis=0):
    return tgt.clone().index_add_(axis, idx, src)
def _segment_sum(src, seg, n):
    out = torch.zeros((n,) + src.shape[1:], dtype=src.dtype)
    return out.index_add_(0, seg, src)
def _pad(x, pw):
    flat = tuple(v for pair in reversed(pw) for v in pair)
    return torch.nn.functional.pad(x, flat)

kernel_name = 'gated_mix__ssm_conv_s5__linear_attn_block__prompt'

def setup_inputs():

    _w = (lambda a: (lambda t: t.to(torch.bfloat16) if t.is_floating_point() else t)(torch.as_tensor(a)))
    def _A_setup():
        B, S, D = 1, 2048, 512
        P = D
        Lambda_re = -0.5 * (lambda _x: torch.exp(torch.as_tensor(_x)))((lambda *s: torch.randn(*s, dtype=torch.bfloat16) * 0.2)(P))
        Lambda_im = (lambda *s: torch.randn(*s, dtype=torch.bfloat16) * 0.8)(P) * 1.0
        B_re = (lambda *s: torch.randn(*s, dtype=torch.bfloat16) * 0.4)(P, D) * (D ** -0.5)
        B_im = (lambda *s: torch.randn(*s, dtype=torch.bfloat16) * 0.4)(P, D) * (D ** -0.5)
        C_re = (lambda *s: torch.randn(*s, dtype=torch.bfloat16) * 0.4)(D, P) * (P ** -0.5)
        C_im = (lambda *s: torch.randn(*s, dtype=torch.bfloat16) * 0.4)(D, P) * (P ** -0.5)
        log_dt = (lambda *s: torch.randn(*s, dtype=torch.bfloat16) * 0.2)(P) * 0.3 - 2.0
        Dskip = (lambda *s: torch.randn(*s, dtype=torch.bfloat16) * 0.05)(D)
        return {
            "x": _w((lambda *s: torch.randn(*s, dtype=torch.bfloat16) * 0.05)(B, S, D)),
            "Lambda_re": _w(Lambda_re),
            "Lambda_im": _w(Lambda_im),
            "B_re": _w(B_re),
            "B_im": _w(B_im),
            "C_re": _w(C_re),
            "C_im": _w(C_im),
            "log_dt": _w(log_dt),
            "Dskip": _w(Dskip),
        }
    _A_in = _A_setup()

    def _B_setup():
        B, S, D = 1, 2048, 512
        return {
            "x": _w((lambda *s: torch.randn(*s, dtype=torch.bfloat16) * 0.05)(B, S, D)),
            "wqkv": _w((lambda *s: torch.randn(*s, dtype=torch.bfloat16) * 0.8)(D, 3 * D)),
            "wo": _w((lambda *s: torch.randn(*s, dtype=torch.bfloat16) * 0.05)(D, D)),
        }
    _B_in = _B_setup()

    return {
        "A_x": _A_in["x"],
        "A_Lambda_re": _A_in["Lambda_re"],
        "A_Lambda_im": _A_in["Lambda_im"],
        "A_B_re": _A_in["B_re"],
        "A_B_im": _A_in["B_im"],
        "A_C_re": _A_in["C_re"],
        "A_C_im": _A_in["C_im"],
        "A_log_dt": _A_in["log_dt"],
        "A_Dskip": _A_in["Dskip"],
        "B_x": _B_in["x"],
        "B_wqkv": _B_in["wqkv"],
        "B_wo": _B_in["wo"],
        "gate_w": _w((lambda *s: torch.randn(*s, dtype=torch.bfloat16) * 0.05)(512) * 16.0),
    }

def reference(A_x, A_Lambda_re, A_Lambda_im, A_B_re, A_B_im, A_C_re, A_C_im, A_log_dt, A_Dskip, B_x, B_wqkv, B_wo, gate_w):
    def _A_ref(x, Lambda_re, Lambda_im, B_re, B_im, C_re, C_im, log_dt, Dskip):
        Bsz, L, H = x.shape
        Lam = Lambda_re + 1j * Lambda_im
        Bmat = B_re + 1j * B_im
        Cmat = C_re + 1j * C_im
        dt = torch.exp(log_dt)
        Lam_bar = torch.exp(dt * Lam)
        B_bar = ((Lam_bar - 1.0) / Lam)[:, None] * Bmat
        Bu = torch.einsum("bld,pd->blp", x + 0j, B_bar)
        h = torch.zeros_like(Bu[:, 0, :])
        hs = []
        for t in range(L):
            h = Lam_bar[None, :] * h + Bu[:, t, :]
            hs.append(h)
        hseq = torch.stack(hs, 1)
        y = 2.0 * torch.einsum("blp,dp->bld", hseq, Cmat).real + x * Dskip[None, None, :]
        return y

    def _B_ref(x, wqkv, wo):
        B, S, D = x.shape
        H = 32; Dh = D // H
        qkv = (lambda x, *d: x.permute(*d))((x @ wqkv).reshape(B, S, 3, H, Dh), 2, 0, 3, 1, 4)
        q, k, v = qkv[0], qkv[1], qkv[2]
        phi = lambda t: torch.where(t > 0, t + 1, torch.exp(t)) + 1e-6
        pq, pk = phi(q), phi(k)
        kv = torch.einsum("bhsd,bhse->bhde", pk, v)
        z = torch.einsum("bhsd->bhd", pk)
        num = torch.einsum("bhqd,bhde->bhqe", pq, kv)
        den = torch.einsum("bhqd,bhd->bhq", pq, z)[..., None] + 1e-6
        o = num / den
        return (lambda x, *d: x.permute(*d))(o, 0, 2, 1, 3).reshape(B, S, D) @ wo

    x = A_x
    g = _sigmoid((x * gate_w).sum(-1, keepdims=True))
    a = _A_ref(x, A_Lambda_re, A_Lambda_im, A_B_re, A_B_im, A_C_re, A_C_im, A_log_dt, A_Dskip)
    b = _B_ref(x, B_wqkv, B_wo)
    return g * a + (1 - g) * b
```

```asm
; @launch grid=(256,1,1) block=(256,1,1) lds=163840
.amdgcn_target "amdgcn-amd-amdhsa--gfx950"
.text
.globl gated_mix__ssm_conv_s5__linear_attn_block__prompt_kernel
.p2align 8
.type gated_mix__ssm_conv_s5__linear_attn_block__prompt_kernel,@function
gated_mix__ssm_conv_s5__linear_attn_block__prompt_kernel:
    s_load_dwordx16 s[4:19], s[0:1], 0x0
    s_load_dwordx16 s[20:35], s[0:1], 0x40
    s_cmp_ge_u32 s2, 0x100
    s_cbranch_scc1 L_end
    v_lshrrev_b32 v4, 6, v0
    v_and_b32 v1, 63, v0
    v_readfirstlane_b32 s3, v4
    s_getpc_b64 s[54:55]
L_pc:
    s_lshr_b32 s41, s2, 3
    v_lshl_add_u32 v4, s41, 2, v4
    v_mad_u32_u24 v4, v4, 4, v1
    v_lshlrev_b32 v4, 7, v4
    v_min_u32 v4, L_end-L_pc, v4
    s_mov_b64 exec, 15
    global_load_dword v12, v4, s[54:55]
    s_mov_b64 exec, -1
    s_bfe_u32 s36, s2, 0x20001
    s_bfe_u32 s41, s2, 0x20003
    s_lshl2_add_u32 s36, s36, s41
    v_lshrrev_b32 v8, 3, v1
    v_and_b32 v9, 7, v1
    v_lshrrev_b32 v4, 2, v8
    v_lshlrev_b32 v4, 5, v4
    v_and_b32 v5, 1, v8
    v_lshl_add_u32 v4, v5, 4, v4
    v_bfe_u32 v5, v8, 1, 1
    v_add_u32 v4, v4, v5
    v_lshrrev_b32 v7, 1, v8
    v_xor_b32 v5, v7, v9
    v_lshlrev_b32 v5, 4, v5
    v_lshl_add_u32 v11, v4, 10, v5
    v_xor_b32 v6, 64, v11
    v_add_u32 v16, 64512, v6
    v_lshl_add_u32 v19, v8, 10, v5
    s_lshl_b32 s51, s36, 17
    s_lshl_b32 s47, s3, 12
    s_add_u32 s45, s51, s47
    s_mov_b32 s58, 0x200000
    s_mov_b32 s59, 0x20000
    s_add_u32 m0, s47, 0x24000
    s_lshr_b32 s39, s2, 5
    s_and_b32 s38, s2, 1
    s_lshl3_add_u32 s39, s38, s39
    s_lshr_b32 s38, s39, 1
    s_lshr_b32 s37, s39, 3
    s_and_b32 s41, s41, 1
    s_xor_b32 s39, s39, s41
    s_and_b32 s39, s39, 7
    s_lshl2_add_u32 s40, s37, s3
    s_lshl4_add_u32 s41, s40, s39
    s_lshl_b32 s41, s41, 7
    s_add_u32 s51, s51, s41
    v_lshlrev_b32 v10, 4, v1
    s_lshr_b32 s52, s2, 1
    s_lshl2_add_u32 s52, s52, s3
    s_and_b32 s41, s52, 0xff
    s_and_b32 s42, s2, 1
    s_lshl_b32 s42, s42, 8
    s_add_u32 s41, s41, s42
    s_lshl_b32 s41, s41, 10
    v_add_u32 v23, s41, v10
    s_mul_i32 s41, s52, 0xc00
    s_lshl1_add_u32 s41, s42, s41
    v_and_b32 v4, 0x200, v10
    v_add3_u32 v24, v4, v10, s41
    s_lshl2_add_u32 s41, s36, s3
    s_and_b32 s41, s41, 31
    s_lshl3_add_u32 s41, s41, s42
    s_lshr_b32 s76, s2, 5
    s_lshl3_add_u32 s41, s41, s76
    s_lshl_b32 s41, s41, 7
    v_add_u32 v29, s41, v19
    s_lshl_b32 s76, 1, s76
    s_waitcnt lgkmcnt(0)
    s_mov_b64 s[56:57], s[4:5]
    s_bitcmp1_b32 s36, 3
    s_cselect_b64 s[0:1], s[12:13], s[10:11]
    s_and_b32 s44, s76, 15
    s_cbranch_scc0 LC_pf_1
    global_load_dwordx4 v[12:15], v24, s[24:25] offset:1024
    global_load_dwordx4 v[12:15], v29, s[0:1]
    buffer_load_dwordx4 v11, s[56:59], s51 offen lds
    buffer_load_dwordx4 v16, s[56:59], s51 offen offset:1024 lds
LC_pf_1:
    s_mov_b32 m0, s47
    s_nop 0
    buffer_load_dwordx4 v11, s[56:59], s45 offen lds
    v_and_b32 v2, 15, v1
    s_lshl2_add_u32 s46, s38, s3
    s_lshl_b32 s41, s46, 5
    v_lshl_add_u32 v25, v2, 1, s41
    s_lshl_b32 s46, s46, 14
    s_lshl_b32 s41, s38, 6
    s_mul_i32 s48, s3, 49152
    s_lshl1_add_u32 s48, s41, s48
    s_bitcmp1_b32 s2, 5
    s_cselect_b64 s[54:55], -1, 0
    s_cselect_b32 s46, s48, s46
    s_cselect_b32 s50, 3, 1
    s_cselect_b32 s49, 0x30000, 64
    s_cselect_b32 s62, 0xffc00, 0
    s_cselect_b32 s66, 0xff800, 0
    buffer_load_dwordx4 v16, s[56:59], s45 offen offset:1024 lds
    s_max_u32 s49, s49, 0x80
    s_add_u32 s62, s62, 0x80000
    s_add_u32 s66, s66, 0x80800
    s_mov_b32 s63, 0x20000
    s_mov_b32 s67, 0x20000
    s_mov_b32 s48, s46
    v_and_b32 v4, 2, v8
    v_cndmask_b32_e64 v4, v7, v4, s[54:55]
    v_xor_b32 v4, v4, v9
    v_mul_u32_u24 v6, s50, v8
    v_lshlrev_b32 v4, 4, v4
    v_lshl_add_u32 v17, v6, 10, v4
    s_lshl_b32 s41, s50, 13
    s_sub_u32 s41, s41, 0x400
    v_xor_b32 v6, 64, v17
    buffer_load_dwordx4 v11, s[56:59], s45 offen offset:2048 lds
    v_add_u32 v18, s41, v6
    v_mov_b32 v26, 0
    v_mov_b32 v27, 0
    v_mov_b32 v28, 0
    s_add_u32 s60, s24, 0x400
    s_addc_u32 s61, s25, 0
    s_sub_u32 s64, s12, 0x800
    s_subb_u32 s65, s13, 0
    s_bitcmp1_b32 s2, 5
    s_cselect_b64 s[60:61], s[60:61], s[10:11]
    s_cselect_b64 s[64:65], s[24:25], s[64:65]
    s_mov_b32 s70, 0x180000
    s_mov_b32 s71, 0x20000
    s_mov_b64 s[68:69], s[24:25]
    v_and_b32 v5, 3, v8
    buffer_load_dwordx4 v16, s[56:59], s45 offen offset:3072 lds
    v_mul_u32_u24 v5, 0xc00, v5
    v_lshl_add_u32 v5, v9, 4, v5
    v_lshrrev_b32 v6, 2, v8
    v_lshl_add_u32 v22, v6, 10, v5
    s_lshr_b32 s42, s2, 3
    s_lshl2_add_u32 s42, s42, s3
    s_mul_i32 s42, s42, 12288
    s_lshr_b32 s41, s38, 2
    s_cmp_eq_u32 s41, 0
    s_cselect_b32 s41, 0, 0x40000000
    s_or_b32 s42, s42, s41
    v_add_u32 v22, s42, v22
    s_and_b32 s44, s76, 15
    s_cbranch_scc0 LC_pf_2
    buffer_load_dwordx4 v[12:15], v22, s[68:71], 0 offen offset:1408
LC_pf_2:
    v_lshrrev_b32 v3, 4, v1
    s_mov_b32 s74, 0x400
    s_mov_b32 s75, 0x20000
    s_bitcmp1_b32 s3, 0
    s_cselect_b64 s[72:73], s[20:21], s[28:29]
    s_bitcmp1_b32 s2, 5
    s_cbranch_scc1 L_typeX
    s_branch L_typeY
.p2align 12
L_typeY:

    global_load_short_d16_hi v26, v25, s[6:7]
    global_load_short_d16_hi v27, v25, s[8:9]
    global_load_short_d16_hi v28, v25, s[18:19]
    s_mov_b32 s82, 0xa00000
    s_mov_b32 s83, 0x20000
    s_mov_b64 s[80:81], s[34:35]
    s_mov_b32 s86, 0x400000
    s_mov_b32 s87, 0x20000
    s_mov_b64 s[84:85], s[30:31]
    s_mov_b32 s90, 0x80000
    s_mov_b32 s91, 0x20000
    s_mov_b64 s[88:89], s[14:15]
    s_mov_b32 s10, 0x80800
    s_mov_b32 s11, 0x20000
    s_sub_u32 s8, s16, 2048
    s_subb_u32 s9, s17, 0
    s_mov_b32 s6, 0x80000
    s_mov_b32 s7, 0x20000
    s_mov_b64 s[4:5], s[26:27]
    s_bitcmp1_b32 s2, 7
    s_cselect_b64 s[96:97], s[16:17], s[14:15]
    s_and_b32 s41, s2, 1
    s_lshl1_add_u32 s52, s52, s41
    s_lshl_b32 s52, s52, 9
    s_lshl2_add_u32 s22, s39, s3
    s_lshl_b32 s22, s22, 14
    s_lshl_b32 s23, s39, 7
    s_lshl_b32 s41, s3, 15
    s_add_u32 s23, s23, s41
    v_xor_b32 v6, 64, v19
    v_add_u32 v20, 7168, v6
    v_and_b32 v5, 6, v8
    v_xor_b32 v5, v5, v9
    v_lshlrev_b32 v5, 4, v5
    v_lshl_add_u32 v21, v8, 10, v5
    s_add_u32 m0, s47, 0x4000
    s_nop 0
    buffer_load_dwordx4 v17, s[60:63], s48 offen lds
    v_lshrrev_b32 v4, 1, v2
    v_xor_b32 v4, v4, v3
    v_lshlrev_b32 v4, 4, v4
    v_lshl_add_u32 v30, v2, 7, v4
    v_xor_b32 v31, 64, v30
    v_add_u32 v32, 0x10000, v30
    v_add_u32 v33, 0x10000, v31
    s_lshl_b32 s41, s40, 11
    v_add_u32 v34, s41, v30
    v_add_u32 v35, s41, v31
    v_add_u32 v36, s41, v32
    v_add_u32 v37, s41, v33
    v_add_u32 v38, s47, v30
    v_add_u32 v39, s47, v31
    v_add_u32 v40, s47, v32
    v_add_u32 v41, s47, v33
    buffer_load_dwordx4 v18, s[60:63], s48 offen offset:1024 lds
    v_lshlrev_b32 v42, 4, v3
    v_add_u32 v42, 0x20000, v42
    s_lshl_b32 s41, s39, 7
    s_add_u32 s41, s41, 0x20400
    v_lshl_add_u32 v43, v2, 1, s41
    v_mov_b32 v72, 0
    v_mov_b32 v73, 0
    v_mov_b32 v74, 0
    v_mov_b32 v75, 0
    v_mov_b32 v56, 0
    v_mov_b32 v57, 0
    v_mov_b32 v58, 0
    v_mov_b32 v59, 0
    v_mov_b32 v60, 0
    v_mov_b32 v61, 0
    v_mov_b32 v62, 0
    buffer_load_dwordx4 v17, s[64:67], s48 offen offset:2048 lds
    v_mov_b32 v63, 0
    v_mov_b32 v64, 0
    v_mov_b32 v65, 0
    v_mov_b32 v66, 0
    v_mov_b32 v67, 0
    v_mov_b32 v68, 0
    v_mov_b32 v69, 0
    v_mov_b32 v70, 0
    v_mov_b32 v71, 0
    s_add_u32 s42, s47, 0x24000
    v_lshrrev_b32 v4, 3, v2
    v_lshlrev_b32 v5, 1, v3
    v_xor_b32 v4, v4, v5
    v_lshlrev_b32 v4, 4, v4
    v_lshl_add_u32 v4, v3, 9, v4
    v_and_b32 v5, 7, v2
    buffer_load_dwordx4 v18, s[64:67], s48 offen offset:3072 lds
    v_lshl_add_u32 v4, v5, 1, v4
    v_add_u32 v45, s42, v4
    v_xor_b32 v46, 16, v45
    v_xor_b32 v47, 32, v45
    v_xor_b32 v48, 48, v45
    v_xor_b32 v49, 64, v45
    v_xor_b32 v50, 80, v45
    v_xor_b32 v51, 96, v45
    v_xor_b32 v52, 112, v45
    s_lshl_b32 s42, s36, 7
    s_lshl1_add_u32 s42, s40, s42
    v_lshl_add_u32 v4, v3, 5, s42
    s_lshl_b32 s42, s39, 6
    v_add_u32 v5, s42, v2
    v_lshlrev_b32 v5, 2, v5
    v_lshl_add_u32 v44, v4, 11, v5
    s_lshr_b32 s44, s47, 2
    s_add_u32 m0, s44, 0x20000
    s_cmp_lt_u32 s3, 2
    s_cbranch_scc0 LY_pf_3
    buffer_load_dwordx4 v10, s[72:75], 0 offen lds
LY_pf_3:
    s_load_dword s43, s[80:81], 0x0
    v_lshlrev_b32 v88, 4, v9
    v_lshl_add_u32 v88, v8, 10, v88
    v_lshlrev_b32 v85, 2, v1
    v_lshlrev_b32 v89, 9, v1
    v_lshlrev_b32 v90, 13, v1
    s_mov_b32 s12, -1
    s_mov_b32 s13, 0
    s_lshl_b32 s16, s36, 13
    s_add_u32 s16, s16, 0x20000
    s_lshl_b32 s17, s38, 10
    s_add_u32 s15, s16, s17
    s_add_u32 s15, s15, 0
    s_mov_b32 s42, s38
    s_lshl2_add_u32 s16, s42, s16
    s_mul_i32 s18, s3, 0
    s_add_u32 s18, s18, s15
    s_add_u32 m0, s47, 0x8000
    s_addk_i32 s45, 0x80
    buffer_load_dwordx4 v11, s[56:59], s45 offen lds
    s_lshl2_add_u32 s17, s36, s17
    s_add_u32 s17, s17, 0x20000
    s_lshl_b32 s44, s3, 7
    s_add_u32 s44, s44, s15
    v_mov_b32 v91, 0
    s_mov_b64 exec, 1
    buffer_atomic_add v91, v85, s[80:83], s44 offen sc1
    s_mov_b64 exec, -1
    v_lshrrev_b32 v4, 1, v2
    v_lshrrev_b32 v5, 1, v3
    v_xor_b32 v4, v4, v5
    v_lshlrev_b32 v4, 4, v4
    v_lshl_add_u32 v4, v2, 7, v4
    v_and_b32 v5, 1, v3
    v_lshl_add_u32 v53, v5, 11, v4
    v_xor_b32 v54, 32, v53
    v_xor_b32 v55, 64, v53
    v_xor_b32 v76, 96, v53
    v_add_u32 v77, 0x10000, v53
    v_add_u32 v78, 0x10000, v54
    v_add_u32 v79, 0x10000, v55
    buffer_load_dwordx4 v16, s[56:59], s45 offen offset:1024 lds
    v_add_u32 v80, 0x10000, v76
    v_lshrrev_b32 v4, 2, v2
    v_lshl_add_u32 v4, v3, 2, v4
    v_and_b32 v5, 6, v4
    v_bfe_u32 v6, v2, 1, 1
    v_xor_b32 v5, v5, v6
    v_lshlrev_b32 v5, 4, v5
    v_lshl_add_u32 v5, v4, 7, v5
    v_and_b32 v6, 1, v2
    v_lshl_add_u32 v5, v6, 3, v5
    v_add_u32 v81, 0x20000, v5
    v_xor_b32 v82, 32, v81
    v_xor_b32 v83, 64, v81
    v_xor_b32 v84, 96, v81
    s_lshl3_add_u32 s14, s36, s40
    s_lshl_b32 s14, s14, 16
    buffer_load_dwordx4 v11, s[56:59], s45 offen offset:2048 lds
    s_add_u32 s14, s14, 0x200000
    s_bfm_b64 s[20:21], s36, 0
    s_mov_b32 s77, 0x10000
    s_mov_b32 s24, 0xffff0000
    s_mov_b32 s25, 0
    s_mov_b32 s26, 0
    s_mov_b32 s27, 0xffff
    s_mov_b32 s28, 0
    s_mov_b32 s29, 0xffff0000
    s_mov_b32 s30, 0xffff0000
    s_mov_b32 s31, 0xffff0000
    s_mov_b32 s32, 0
    s_mov_b32 s33, -1
    s_lshr_b32 s42, s46, 7
    s_add_u32 s42, s42, 0x10000
    v_lshl_add_u32 v180, v2, 3, s42
    buffer_load_dwordx4 v16, s[56:59], s45 offen offset:3072 lds
    v_mov_b32 v181, s36
    v_lshl_add_u32 v189, v181, 12, v180
    v_mov_b32 v183, 0x7ffffff0
    s_mov_b32 s19, 0x07060500
    s_mov_b32 s34, 0x07060501
    s_mov_b32 s35, 0x0c0c0400
    v_add_u32 v182, 1, v3
    v_cmp_le_u32_e64 s[54:55], v182, v181
    v_sub_u32 v182, v181, v182
    v_lshl_add_u32 v182, v182, 12, v180
    v_cndmask_b32_e64 v95, v183, v182, s[54:55]
    v_cndmask_b32_e64 v192, 0, -1, s[54:55]
    v_add_u32 v182, 5, v3
    v_cmp_le_u32_e64 s[54:55], v182, v181
    v_sub_u32 v182, v181, v182
    v_lshl_add_u32 v182, v182, 12, v180
    s_addk_i32 m0, 0x4000
    s_add_u32 s48, s48, s49
    buffer_load_dwordx4 v17, s[60:63], s48 offen lds
    v_cndmask_b32_e64 v186, v183, v182, s[54:55]
    v_cndmask_b32_e64 v193, 0, -1, s[54:55]
    v_add_u32 v182, 9, v3
    v_cmp_le_u32_e64 s[54:55], v182, v181
    v_sub_u32 v182, v181, v182
    v_lshl_add_u32 v182, v182, 12, v180
    v_cndmask_b32_e64 v187, v183, v182, s[54:55]
    v_cndmask_b32_e64 v194, 0, -1, s[54:55]
    v_add_u32 v182, 13, v3
    v_cmp_le_u32_e64 s[54:55], v182, v181
    v_sub_u32 v182, v181, v182
    v_lshl_add_u32 v182, v182, 12, v180
    v_cndmask_b32_e64 v188, v183, v182, s[54:55]
    v_cndmask_b32_e64 v195, 0, -1, s[54:55]
    s_add_u32 s42, s47, 0x24000
    v_mul_u32_u24 v180, 0x140, v3
    buffer_load_dwordx4 v18, s[60:63], s48 offen offset:1024 lds
    v_lshl_add_u32 v180, v2, 4, v180
    v_add_u32 v191, s42, v180
    v_and_b32 v180, 3, v2
    v_mul_u32_u24 v180, 0x140, v180
    v_lshrrev_b32 v181, 1, v3
    v_lshl_add_u32 v180, v181, 7, v180
    v_lshrrev_b32 v181, 2, v2
    v_lshl_add_u32 v180, v181, 4, v180
    v_and_b32 v181, 1, v3
    v_lshl_add_u32 v180, v181, 3, v180
    v_add_u32 v196, s42, v180
    s_lshr_b32 s42, s46, 14
    s_mul_i32 s41, s42, 43
    s_lshr_b32 s41, s41, 8
    s_mul_i32 s44, s41, 6
    s_sub_u32 s44, s42, s44
    s_cmp_ge_u32 s44, 3
    s_addc_u32 s44, s44, 0
    s_lshl_b32 s41, s41, 6
    s_add_u32 s41, s41, s44
    s_lshl_b32 s50, s41, 7
    s_lshl_b32 s42, s36, 19
    s_add_u32 s50, s50, s42
    s_add_u32 s50, s50, 0x200000
    buffer_load_dwordx4 v17, s[64:67], s48 offen offset:2048 lds
    s_waitcnt vmcnt(12)
    v_mul_f32 v28, 0x3fb8aa3b, v28
    v_exp_f32 v28, v28
    s_nop 0
    v_cvt_pk_bf16_f32 v28, v28, v28
    v_and_b32 v28, 0xffff0000, v28
    v_mul_f32 v180, v28, v26
    v_mul_f32 v181, v28, v27
    v_mul_f32 v180, 0x3fb8aa3b, v180
    v_mul_f32 v181, 0.15915494, v181
    v_exp_f32 v180, v180
    v_fract_f32 v181, v181
    v_cos_f32 v164, v181
    v_sin_f32 v165, v181
    v_mul_f32 v164, v180, v164
    v_mul_f32 v165, v180, v165
    v_mul_f32 v182, v26, v26
    v_fmac_f32 v182, v27, v27
    buffer_load_dwordx4 v18, s[64:67], s48 offen offset:3072 lds
    s_and_b32 s44, s76, 48
    s_cbranch_scc0 LY_pf_4
    s_add_u32 m0, s47, 0x24000
    global_load_dwordx4 v[12:15], v24, s[68:69] offset:1024
    global_load_dwordx4 v[12:15], v29, s[0:1]
    buffer_load_dwordx4 v11, s[56:59], s51 offen lds
    buffer_load_dwordx4 v16, s[56:59], s51 offen offset:1024 lds
    buffer_load_dwordx4 v[12:15], v22, s[68:71], 0 offen offset:1408
    s_add_u32 m0, s47, 0xc000
    s_nop 0
LY_pf_4:
    v_rcp_f32 v182, v182
    v_add_f32 v180, -1.0, v164
    v_add_f32 v182, v182, v182
    v_mul_f32 v174, v180, v26
    v_mul_f32 v175, v165, v26
    v_fmac_f32 v174, v165, v27
    v_fma_f32 v175, -v180, v27, v175
    v_mul_f32 v174, v182, v174
    v_mul_f32 v175, v182, v175
    v_pk_mul_f32 v[180:181], v[164:165], v[164:165] op_sel_hi:[0,1]
    v_pk_fma_f32 v[180:181], v[164:165], v[164:165], v[180:181] op_sel:[1,1,0] op_sel_hi:[1,0,1] neg_lo:[1,0,0]
    v_pk_mul_f32 v[182:183], v[180:181], v[180:181] op_sel_hi:[0,1]
    v_pk_fma_f32 v[182:183], v[180:181], v[180:181], v[182:183] op_sel:[1,1,0] op_sel_hi:[1,0,1] neg_lo:[1,0,0]
    v_pk_mul_f32 v[180:181], v[182:183], v[182:183] op_sel_hi:[0,1]
    v_pk_fma_f32 v[180:181], v[182:183], v[182:183], v[180:181] op_sel:[1,1,0] op_sel_hi:[1,0,1] neg_lo:[1,0,0]
    v_pk_mul_f32 v[166:167], v[180:181], v[180:181] op_sel_hi:[0,1]
    v_pk_fma_f32 v[166:167], v[180:181], v[180:181], v[166:167] op_sel:[1,1,0] op_sel_hi:[1,0,1] neg_lo:[1,0,0]
    v_pk_mul_f32 v[168:169], v[166:167], v[166:167] op_sel_hi:[0,1]
    v_pk_fma_f32 v[168:169], v[166:167], v[166:167], v[168:169] op_sel:[1,1,0] op_sel_hi:[1,0,1] neg_lo:[1,0,0]
    v_pk_mul_f32 v[180:181], v[168:169], v[168:169] op_sel_hi:[0,1]
    v_pk_fma_f32 v[180:181], v[168:169], v[168:169], v[180:181] op_sel:[1,1,0] op_sel_hi:[1,0,1] neg_lo:[1,0,0]
    v_cndmask_b32_e64 v182, 1.0, v168, s[30:31]
    v_cndmask_b32_e64 v183, 0, v169, s[30:31]
    v_cndmask_b32_e64 v184, 1.0, v180, s[32:33]
    v_cndmask_b32_e64 v185, 0, v181, s[32:33]
    v_pk_mul_f32 v[26:27], v[182:183], v[184:185] op_sel_hi:[0,1]
    v_pk_fma_f32 v[26:27], v[182:183], v[184:185], v[26:27] op_sel:[1,1,0] op_sel_hi:[1,0,1] neg_lo:[1,0,0]
    v_pk_mul_f32 v[182:183], v[180:181], v[180:181] op_sel_hi:[0,1]
    v_pk_fma_f32 v[182:183], v[180:181], v[180:181], v[182:183] op_sel:[1,1,0] op_sel_hi:[1,0,1] neg_lo:[1,0,0]
    v_pk_mul_f32 v[180:181], v[182:183], v[182:183] op_sel_hi:[0,1]
    v_pk_fma_f32 v[180:181], v[182:183], v[182:183], v[180:181] op_sel:[1,1,0] op_sel_hi:[1,0,1] neg_lo:[1,0,0]
    v_pk_mul_f32 v[170:171], v[180:181], v[180:181] op_sel_hi:[0,1]
    v_pk_fma_f32 v[170:171], v[180:181], v[180:181], v[170:171] op_sel:[1,1,0] op_sel_hi:[1,0,1] neg_lo:[1,0,0]
    v_cndmask_b32_e64 v182, 1.0, v182, s[30:31]
    v_cndmask_b32_e64 v183, 0, v183, s[30:31]
    v_cndmask_b32_e64 v180, 1.0, v180, s[32:33]
    v_cndmask_b32_e64 v181, 0, v181, s[32:33]
    v_pk_mul_f32 v[172:173], v[182:183], v[180:181] op_sel_hi:[0,1]
    v_pk_fma_f32 v[172:173], v[182:183], v[180:181], v[172:173] op_sel:[1,1,0] op_sel_hi:[1,0,1] neg_lo:[1,0,0]
    v_mul_f32 v176, v174, v26
    v_mul_f32 v178, v174, v27
    v_fma_f32 v176, -v175, v27, v176
    v_fmac_f32 v178, v175, v26
    v_mul_f32 v177, v176, v166
    v_mul_f32 v179, v176, v167
    v_fma_f32 v177, -v178, v167, v177
    v_fmac_f32 v179, v178, v166
    s_waitcnt vmcnt(9)
    s_barrier
    ds_read_b128 v[208:211], v38 offset:16384
    ds_read_b128 v[212:215], v38 offset:18432
    ds_read_b128 a[128:131], v30 offset:0
    ds_read_b128 a[132:135], v30 offset:2048
    s_addk_i32 m0, 0x4000
    s_addk_i32 s45, 0x80
    buffer_load_dwordx4 v11, s[56:59], s45 offen lds
    ds_read_b128 a[136:139], v30 offset:4096
    ds_read_b128 a[140:143], v30 offset:6144
    ds_read_b128 a[144:147], v30 offset:8192
    ds_read_b128 a[148:151], v30 offset:10240
    buffer_load_dwordx4 v16, s[56:59], s45 offen offset:1024 lds
    ds_read_b128 a[152:155], v30 offset:12288
    ds_read_b128 a[156:159], v30 offset:14336
    ds_read_b128 a[64:67], v34 offset:0
    ds_read_b128 a[0:3], v42 offset:0
    ds_read_b128 a[4:7], v42 offset:64
    ds_read_b128 a[8:11], v42 offset:128
    ds_read_b128 a[12:15], v42 offset:192
    ds_read_b128 a[16:19], v42 offset:256
    ds_read_b128 a[20:23], v42 offset:320
    ds_read_b128 a[24:27], v42 offset:384
    ds_read_b128 a[28:31], v42 offset:448
    s_waitcnt lgkmcnt(0)
    v_mfma_f32_16x16x32_bf16 v[96:99], a[128:131], v[208:211], 0
    ds_read_b128 a[160:163], v31 offset:0
    ds_read_b128 a[164:167], v31 offset:2048
    v_mfma_f32_16x16x32_bf16 v[128:131], a[128:131], v[212:215], 0
    buffer_load_dwordx4 v11, s[56:59], s45 offen offset:2048 lds
    v_mfma_f32_16x16x32_bf16 v[100:103], a[132:135], v[208:211], 0
    ds_read_b128 a[168:171], v31 offset:4096
    ds_read_b128 a[172:175], v31 offset:6144
    v_mfma_f32_16x16x32_bf16 v[132:135], a[132:135], v[212:215], 0
    buffer_load_dwordx4 v16, s[56:59], s45 offen offset:3072 lds
    v_mfma_f32_16x16x32_bf16 v[104:107], a[136:139], v[208:211], 0
    ds_read_b128 a[176:179], v31 offset:8192
    ds_read_b128 a[180:183], v31 offset:10240
    v_mfma_f32_16x16x32_bf16 v[136:139], a[136:139], v[212:215], 0
    s_addk_i32 m0, 0x4000
    s_add_u32 s48, s48, s49
    buffer_load_dwordx4 v17, s[60:63], s48 offen lds
    v_mfma_f32_16x16x32_bf16 v[108:111], a[140:143], v[208:211], 0
    ds_read_b128 a[184:187], v31 offset:12288
    ds_read_b128 a[188:191], v31 offset:14336
    v_mfma_f32_16x16x32_bf16 v[140:143], a[140:143], v[212:215], 0
    buffer_load_dwordx4 v18, s[60:63], s48 offen offset:1024 lds
    v_mfma_f32_16x16x32_bf16 v[112:115], a[144:147], v[208:211], 0
    ds_read_b128 v[216:219], v39 offset:16384
    ds_read_b128 v[220:223], v39 offset:18432
    v_mfma_f32_16x16x32_bf16 v[144:147], a[144:147], v[212:215], 0
    buffer_load_dwordx4 v17, s[64:67], s48 offen offset:2048 lds
    v_mfma_f32_16x16x32_bf16 v[116:119], a[148:151], v[208:211], 0
    ds_read_b128 a[68:71], v35 offset:0
    ds_read_b128 a[32:35], v42 offset:512
    v_mfma_f32_16x16x32_bf16 v[148:151], a[148:151], v[212:215], 0
    buffer_load_dwordx4 v18, s[64:67], s48 offen offset:3072 lds
    s_and_b32 s44, s76, 192
    s_cbranch_scc0 LY_pf_5
    s_add_u32 m0, s47, 0x24000
    global_load_dwordx4 v[12:15], v24, s[68:69] offset:1024
    global_load_dwordx4 v[12:15], v29, s[0:1]
    buffer_load_dwordx4 v11, s[56:59], s51 offen lds
    buffer_load_dwordx4 v16, s[56:59], s51 offen offset:1024 lds
    buffer_load_dwordx4 v[12:15], v22, s[68:71], 0 offen offset:1408
    s_add_u32 m0, s47, 0x14000
    s_nop 0
LY_pf_5:
    v_mfma_f32_16x16x32_bf16 v[120:123], a[152:155], v[208:211], 0
    s_addk_i32 m0, 0x4000
    v_mfma_f32_16x16x32_bf16 v[152:155], a[152:155], v[212:215], 0
    s_addk_i32 s45, 0x80
    buffer_load_dwordx4 v11, s[56:59], s45 offen lds
    v_mfma_f32_16x16x32_bf16 v[124:127], a[156:159], v[208:211], 0
    v_mfma_f32_16x16x32_bf16 v[156:159], a[156:159], v[212:215], 0
    buffer_load_dwordx4 v16, s[56:59], s45 offen offset:1024 lds
    s_waitcnt vmcnt(10) lgkmcnt(0)
    s_barrier
    v_mfma_f32_16x16x32_bf16 v[96:99], a[160:163], v[216:219], v[96:99]
    ds_read_b128 v[208:211], v38 offset:49152
    ds_read_b128 v[212:215], v38 offset:51200
    v_mfma_f32_16x16x32_bf16 v[128:131], a[160:163], v[220:223], v[128:131]
    buffer_load_dwordx4 v11, s[56:59], s45 offen offset:2048 lds
    v_mfma_f32_16x16x32_bf16 v[100:103], a[164:167], v[216:219], v[100:103]
    ds_read_b128 a[128:131], v30 offset:32768
    ds_read_b128 a[36:39], v42 offset:576
    v_mfma_f32_16x16x32_bf16 v[132:135], a[164:167], v[220:223], v[132:135]
    ds_read_b128 a[132:135], v30 offset:34816
    ds_read_b128 a[40:43], v42 offset:640
    v_mfma_f32_16x16x32_bf16 v[104:107], a[168:171], v[216:219], v[104:107]
    ds_read_b128 a[136:139], v30 offset:36864
    ds_read_b128 a[44:47], v42 offset:704
    v_mfma_f32_16x16x32_bf16 v[136:139], a[168:171], v[220:223], v[136:139]
    buffer_load_dwordx4 v16, s[56:59], s45 offen offset:3072 lds
    v_mfma_f32_16x16x32_bf16 v[108:111], a[172:175], v[216:219], v[108:111]
    ds_read_b128 a[140:143], v30 offset:38912
    s_addk_i32 m0, 0x4000
    v_mfma_f32_16x16x32_bf16 v[140:143], a[172:175], v[220:223], v[140:143]
    ds_read_b128 a[144:147], v30 offset:40960
    s_add_u32 s48, s48, s49
    v_mfma_f32_16x16x32_bf16 v[112:115], a[176:179], v[216:219], v[112:115]
    ds_read_b128 a[148:151], v30 offset:43008
    ds_read_b128 a[48:51], v42 offset:768
    v_mfma_f32_16x16x32_bf16 v[144:147], a[176:179], v[220:223], v[144:147]
    buffer_load_dwordx4 v17, s[60:63], s48 offen lds
    v_mfma_f32_16x16x32_bf16 v[116:119], a[180:183], v[216:219], v[116:119]
    ds_read_b128 a[152:155], v30 offset:45056
    ds_read_b128 a[52:55], v42 offset:832
    v_mfma_f32_16x16x32_bf16 v[148:151], a[180:183], v[220:223], v[148:151]
    ds_read_b128 a[156:159], v30 offset:47104
    ds_read_b128 a[56:59], v42 offset:896
    v_mfma_f32_16x16x32_bf16 v[120:123], a[184:187], v[216:219], v[120:123]
    ds_read_b128 a[72:75], v34 offset:32768
    ds_read_b128 a[60:63], v42 offset:960
    v_mfma_f32_16x16x32_bf16 v[152:155], a[184:187], v[220:223], v[152:155]
    buffer_load_dwordx4 v18, s[60:63], s48 offen offset:1024 lds
    v_mfma_f32_16x16x32_bf16 v[124:127], a[188:191], v[216:219], v[124:127]
    ds_read_b128 a[160:163], v31 offset:32768
    ds_read_u16_d16_hi v72, v43 offset:0
    v_mfma_f32_16x16x32_bf16 v[156:159], a[188:191], v[220:223], v[156:159]
    ds_read_b128 a[164:167], v31 offset:34816
    s_waitcnt lgkmcnt(12)
    v_mfma_f32_16x16x32_bf16 v[96:99], a[128:131], v[208:211], v[96:99]
    ds_read_b128 a[168:171], v31 offset:36864
    ds_read_u16_d16_hi v73, v43 offset:32
    v_mfma_f32_16x16x32_bf16 v[128:131], a[128:131], v[212:215], v[128:131]
    buffer_load_dwordx4 v17, s[64:67], s48 offen offset:2048 lds
    v_mfma_f32_16x16x32_bf16 v[100:103], a[132:135], v[208:211], v[100:103]
    ds_read_b128 a[172:175], v31 offset:38912
    ds_read_u16_d16_hi v74, v43 offset:64
    v_mfma_f32_16x16x32_bf16 v[132:135], a[132:135], v[212:215], v[132:135]
    ds_read_b128 a[176:179], v31 offset:40960
    ds_read_u16_d16_hi v75, v43 offset:96
    v_mfma_f32_16x16x32_bf16 v[104:107], a[136:139], v[208:211], v[104:107]
    ds_read_b128 a[180:183], v31 offset:43008
    s_add_u32 s43, s43, 0x9e3779b9
    v_mfma_f32_16x16x32_bf16 v[136:139], a[136:139], v[212:215], v[136:139]
    buffer_load_dwordx4 v18, s[64:67], s48 offen offset:3072 lds
    v_mfma_f32_16x16x32_bf16 v[108:111], a[140:143], v[208:211], v[108:111]
    ds_read_b128 a[184:187], v31 offset:45056
    s_mov_b32 m0, s47
    v_mfma_f32_16x16x32_bf16 v[140:143], a[140:143], v[212:215], v[140:143]
    ds_read_b128 a[188:191], v31 offset:47104
    s_waitcnt lgkmcnt(15)
    v_mfma_f32_16x16x32_bf16 v[112:115], a[144:147], v[208:211], v[112:115]
    ds_read_b128 v[216:219], v39 offset:49152
    s_addk_i32 s45, 0x80
    v_mfma_f32_16x16x32_bf16 v[144:147], a[144:147], v[212:215], v[144:147]
    buffer_load_dwordx4 v11, s[56:59], s45 offen lds
    v_mfma_f32_16x16x32_bf16 v[116:119], a[148:151], v[208:211], v[116:119]
    ds_read_b128 v[220:223], v39 offset:51200
    v_mov_b32 v91, s43
    v_mfma_f32_16x16x32_bf16 v[148:151], a[148:151], v[212:215], v[148:151]
    ds_read_b128 a[76:79], v35 offset:32768
    v_mov_b32 v190, s43
    v_mfma_f32_16x16x32_bf16 v[120:123], a[152:155], v[208:211], v[120:123]
    v_mfma_f32_16x16x32_bf16 v[152:155], a[152:155], v[212:215], v[152:155]
    buffer_load_dwordx4 v16, s[56:59], s45 offen offset:1024 lds
    v_mfma_f32_16x16x32_bf16 v[124:127], a[156:159], v[208:211], v[124:127]
    v_mfma_f32_16x16x32_bf16 v[156:159], a[156:159], v[212:215], v[156:159]
    s_waitcnt vmcnt(10) lgkmcnt(0)
    s_barrier
    v_mfma_f32_16x16x32_bf16 v[96:99], a[160:163], v[216:219], v[96:99]
    ds_read_b128 v[208:211], v40 offset:16384
    ds_read_b128 v[212:215], v40 offset:18432
    v_mfma_f32_16x16x32_bf16 v[128:131], a[160:163], v[220:223], v[128:131]
    buffer_load_dwordx4 v11, s[56:59], s45 offen offset:2048 lds
    v_mfma_f32_16x16x32_bf16 v[100:103], a[164:167], v[216:219], v[100:103]
    ds_read_b128 a[128:131], v32 offset:0
    v_and_b32 v190, 0xffff, v190
    v_mfma_f32_16x16x32_bf16 v[132:135], a[164:167], v[220:223], v[132:135]
    ds_read_b128 a[132:135], v32 offset:2048
    v_and_b32 v192, v192, v190
    v_mfma_f32_16x16x32_bf16 v[104:107], a[168:171], v[216:219], v[104:107]
    ds_read_b128 a[136:139], v32 offset:4096
    v_and_b32 v193, v193, v190
    v_mfma_f32_16x16x32_bf16 v[136:139], a[168:171], v[220:223], v[136:139]
    buffer_load_dwordx4 v16, s[56:59], s45 offen offset:3072 lds
    v_mfma_f32_16x16x32_bf16 v[108:111], a[172:175], v[216:219], v[108:111]
    ds_read_b128 a[140:143], v32 offset:6144
    s_addk_i32 m0, 0x4000
    v_mfma_f32_16x16x32_bf16 v[140:143], a[172:175], v[220:223], v[140:143]
    ds_read_b128 a[144:147], v32 offset:8192
    s_add_u32 s48, s48, s49
    v_mfma_f32_16x16x32_bf16 v[112:115], a[176:179], v[216:219], v[112:115]
    ds_read_b128 a[148:151], v32 offset:10240
    v_and_b32 v194, v194, v190
    v_mfma_f32_16x16x32_bf16 v[144:147], a[176:179], v[220:223], v[144:147]
    buffer_load_dwordx4 v17, s[60:63], s48 offen lds
    v_mfma_f32_16x16x32_bf16 v[116:119], a[180:183], v[216:219], v[116:119]
    ds_read_b128 a[152:155], v32 offset:12288
    v_and_b32 v195, v195, v190
    v_mfma_f32_16x16x32_bf16 v[148:151], a[180:183], v[220:223], v[148:151]
    ds_read_b128 a[156:159], v32 offset:14336
    v_mfma_f32_16x16x32_bf16 v[120:123], a[184:187], v[216:219], v[120:123]
    ds_read_b128 a[80:83], v36 offset:0
    v_mfma_f32_16x16x32_bf16 v[152:155], a[184:187], v[220:223], v[152:155]
    buffer_load_dwordx4 v18, s[60:63], s48 offen offset:1024 lds
    v_mfma_f32_16x16x32_bf16 v[124:127], a[188:191], v[216:219], v[124:127]
    ds_read_b128 a[160:163], v33 offset:0
    v_mfma_f32_16x16x32_bf16 v[156:159], a[188:191], v[220:223], v[156:159]
    ds_read_b128 a[164:167], v33 offset:2048
    s_waitcnt lgkmcnt(7)
    v_mfma_f32_16x16x32_bf16 v[96:99], a[128:131], v[208:211], v[96:99]
    ds_read_b128 a[168:171], v33 offset:4096
    v_mfma_f32_16x16x32_bf16 v[128:131], a[128:131], v[212:215], v[128:131]
    buffer_load_dwordx4 v17, s[64:67], s48 offen offset:2048 lds
    v_mfma_f32_16x16x32_bf16 v[100:103], a[132:135], v[208:211], v[100:103]
    ds_read_b128 a[172:175], v33 offset:6144
    v_mfma_f32_16x16x32_bf16 v[132:135], a[132:135], v[212:215], v[132:135]
    ds_read_b128 a[176:179], v33 offset:8192
    v_mfma_f32_16x16x32_bf16 v[104:107], a[136:139], v[208:211], v[104:107]
    ds_read_b128 a[180:183], v33 offset:10240
    v_mfma_f32_16x16x32_bf16 v[136:139], a[136:139], v[212:215], v[136:139]
    buffer_load_dwordx4 v18, s[64:67], s48 offen offset:3072 lds
    v_lshrrev_b32 v25, 5, v1
    v_mul_u32_u24 v4, 785408, v25
    v_add_u32 v5, v4, v24
    v_add_u32 v6, v4, v22
    v_mul_u32_u24 v4, 261632, v25
    v_add_u32 v4, v4, v10
    s_and_b32 s44, s76, 3
    s_cbranch_scc0 LY_pf_6
    buffer_load_dwordx4 v[12:15], v5, s[68:71], 0 offen
    buffer_load_dwordx4 v[12:15], v6, s[68:71], 0 offen offset:384
    buffer_load_dwordx4 v[12:15], v23, s[88:91], 0 offen
    buffer_load_dwordx4 v[12:15], v23, s[8:11], 0 offen offset:2048
    buffer_load_dwordx4 v[12:15], v4, s[4:7], s52 offen
LY_pf_6:
    v_mfma_f32_16x16x32_bf16 v[108:111], a[140:143], v[208:211], v[108:111]
    ds_read_b128 a[184:187], v33 offset:12288
    s_addk_i32 m0, 0x4000
    v_mfma_f32_16x16x32_bf16 v[140:143], a[140:143], v[212:215], v[140:143]
    ds_read_b128 a[188:191], v33 offset:14336
    s_waitcnt lgkmcnt(9)
    v_mfma_f32_16x16x32_bf16 v[112:115], a[144:147], v[208:211], v[112:115]
    ds_read_b128 v[216:219], v41 offset:16384
    s_addk_i32 s45, 0x80
    v_mfma_f32_16x16x32_bf16 v[144:147], a[144:147], v[212:215], v[144:147]
    buffer_load_dwordx4 v11, s[56:59], s45 offen lds
    v_mfma_f32_16x16x32_bf16 v[116:119], a[148:151], v[208:211], v[116:119]
    ds_read_b128 v[220:223], v41 offset:18432
    v_mfma_f32_16x16x32_bf16 v[148:151], a[148:151], v[212:215], v[148:151]
    ds_read_b128 a[84:87], v37 offset:0
    v_mfma_f32_16x16x32_bf16 v[120:123], a[152:155], v[208:211], v[120:123]
    v_mfma_f32_16x16x32_bf16 v[152:155], a[152:155], v[212:215], v[152:155]
    buffer_load_dwordx4 v16, s[56:59], s45 offen offset:1024 lds
    v_mfma_f32_16x16x32_bf16 v[124:127], a[156:159], v[208:211], v[124:127]
    v_mfma_f32_16x16x32_bf16 v[156:159], a[156:159], v[212:215], v[156:159]
    s_waitcnt vmcnt(10) lgkmcnt(0)
    s_barrier
    v_mfma_f32_16x16x32_bf16 v[96:99], a[160:163], v[216:219], v[96:99]
    ds_read_b128 v[208:211], v40 offset:49152
    ds_read_b128 v[212:215], v40 offset:51200
    v_mfma_f32_16x16x32_bf16 v[128:131], a[160:163], v[220:223], v[128:131]
    buffer_load_dwordx4 v11, s[56:59], s45 offen offset:2048 lds
    v_mfma_f32_16x16x32_bf16 v[100:103], a[164:167], v[216:219], v[100:103]
    ds_read_b128 a[128:131], v32 offset:32768
    v_mfma_f32_16x16x32_bf16 v[132:135], a[164:167], v[220:223], v[132:135]
    ds_read_b128 a[132:135], v32 offset:34816
    v_mfma_f32_16x16x32_bf16 v[104:107], a[168:171], v[216:219], v[104:107]
    ds_read_b128 a[136:139], v32 offset:36864
    v_mfma_f32_16x16x32_bf16 v[136:139], a[168:171], v[220:223], v[136:139]
    buffer_load_dwordx4 v16, s[56:59], s45 offen offset:3072 lds
    v_mfma_f32_16x16x32_bf16 v[108:111], a[172:175], v[216:219], v[108:111]
    ds_read_b128 a[140:143], v32 offset:38912
    s_addk_i32 m0, 0x4000
    v_mfma_f32_16x16x32_bf16 v[140:143], a[172:175], v[220:223], v[140:143]
    ds_read_b128 a[144:147], v32 offset:40960
    s_add_u32 s48, s48, s49
    v_mfma_f32_16x16x32_bf16 v[112:115], a[176:179], v[216:219], v[112:115]
    ds_read_b128 a[148:151], v32 offset:43008
    v_mfma_f32_16x16x32_bf16 v[144:147], a[176:179], v[220:223], v[144:147]
    buffer_load_dwordx4 v17, s[60:63], s48 offen lds
    v_mfma_f32_16x16x32_bf16 v[116:119], a[180:183], v[216:219], v[116:119]
    ds_read_b128 a[152:155], v32 offset:45056
    v_mfma_f32_16x16x32_bf16 v[148:151], a[180:183], v[220:223], v[148:151]
    ds_read_b128 a[156:159], v32 offset:47104
    v_mfma_f32_16x16x32_bf16 v[120:123], a[184:187], v[216:219], v[120:123]
    ds_read_b128 a[88:91], v36 offset:32768
    v_mfma_f32_16x16x32_bf16 v[152:155], a[184:187], v[220:223], v[152:155]
    buffer_load_dwordx4 v18, s[60:63], s48 offen offset:1024 lds
    v_mfma_f32_16x16x32_bf16 v[124:127], a[188:191], v[216:219], v[124:127]
    ds_read_b128 a[160:163], v33 offset:32768
    v_mfma_f32_16x16x32_bf16 v[156:159], a[188:191], v[220:223], v[156:159]
    ds_read_b128 a[164:167], v33 offset:34816
    s_waitcnt lgkmcnt(7)
    v_mfma_f32_16x16x32_bf16 v[96:99], a[128:131], v[208:211], v[96:99]
    ds_read_b128 a[168:171], v33 offset:36864
    v_mfma_f32_16x16x32_bf16 v[128:131], a[128:131], v[212:215], v[128:131]
    buffer_load_dwordx4 v17, s[64:67], s48 offen offset:2048 lds
    v_mfma_f32_16x16x32_bf16 v[100:103], a[132:135], v[208:211], v[100:103]
    ds_read_b128 a[172:175], v33 offset:38912
    v_mfma_f32_16x16x32_bf16 v[132:135], a[132:135], v[212:215], v[132:135]
    ds_read_b128 a[176:179], v33 offset:40960
    v_mfma_f32_16x16x32_bf16 v[104:107], a[136:139], v[208:211], v[104:107]
    ds_read_b128 a[180:183], v33 offset:43008
    v_mfma_f32_16x16x32_bf16 v[136:139], a[136:139], v[212:215], v[136:139]
    buffer_load_dwordx4 v18, s[64:67], s48 offen offset:3072 lds
    s_and_b32 s44, s76, 12
    s_cbranch_scc0 LY_pf_7
    buffer_load_dwordx4 v[12:15], v5, s[68:71], 0 offen
    buffer_load_dwordx4 v[12:15], v6, s[68:71], 0 offen offset:384
    buffer_load_dwordx4 v[12:15], v23, s[88:91], 0 offen
    buffer_load_dwordx4 v[12:15], v23, s[8:11], 0 offen offset:2048
    buffer_load_dwordx4 v[12:15], v4, s[4:7], s52 offen
LY_pf_7:
    v_mfma_f32_16x16x32_bf16 v[108:111], a[140:143], v[208:211], v[108:111]
    ds_read_b128 a[184:187], v33 offset:45056
    s_addk_i32 m0, 0x4000
    v_mfma_f32_16x16x32_bf16 v[140:143], a[140:143], v[212:215], v[140:143]
    ds_read_b128 a[188:191], v33 offset:47104
    s_waitcnt lgkmcnt(9)
    v_mfma_f32_16x16x32_bf16 v[112:115], a[144:147], v[208:211], v[112:115]
    ds_read_b128 v[216:219], v41 offset:49152
    s_addk_i32 s45, 0x80
    v_mfma_f32_16x16x32_bf16 v[144:147], a[144:147], v[212:215], v[144:147]
    buffer_load_dwordx4 v11, s[56:59], s45 offen lds
    v_mfma_f32_16x16x32_bf16 v[116:119], a[148:151], v[208:211], v[116:119]
    ds_read_b128 v[220:223], v41 offset:51200
    v_mfma_f32_16x16x32_bf16 v[148:151], a[148:151], v[212:215], v[148:151]
    ds_read_b128 a[92:95], v37 offset:32768
    v_mfma_f32_16x16x32_bf16 v[120:123], a[152:155], v[208:211], v[120:123]
    v_mfma_f32_16x16x32_bf16 v[152:155], a[152:155], v[212:215], v[152:155]
    buffer_load_dwordx4 v16, s[56:59], s45 offen offset:1024 lds
    v_mfma_f32_16x16x32_bf16 v[124:127], a[156:159], v[208:211], v[124:127]
    v_mfma_f32_16x16x32_bf16 v[156:159], a[156:159], v[212:215], v[156:159]
    s_waitcnt vmcnt(10) lgkmcnt(0)
    s_barrier
    v_mfma_f32_16x16x32_bf16 v[96:99], a[160:163], v[216:219], v[96:99]
    ds_read_b128 v[208:211], v38 offset:16384
    ds_read_b128 v[212:215], v38 offset:18432
    v_mfma_f32_16x16x32_bf16 v[128:131], a[160:163], v[220:223], v[128:131]
    buffer_load_dwordx4 v11, s[56:59], s45 offen offset:2048 lds
    v_mfma_f32_16x16x32_bf16 v[100:103], a[164:167], v[216:219], v[100:103]
    ds_read_b128 a[128:131], v30 offset:0
    ds_read_u16_d16_hi v56, v45 offset:0
    v_mfma_f32_16x16x32_bf16 v[132:135], a[164:167], v[220:223], v[132:135]
    ds_read_b128 a[132:135], v30 offset:2048
    ds_read_u16_d16_hi v57, v45 offset:128
    v_mfma_f32_16x16x32_bf16 v[104:107], a[168:171], v[216:219], v[104:107]
    ds_read_b128 a[136:139], v30 offset:4096
    ds_read_u16_d16_hi v58, v46 offset:256
    v_mfma_f32_16x16x32_bf16 v[136:139], a[168:171], v[220:223], v[136:139]
    buffer_load_dwordx4 v16, s[56:59], s45 offen offset:3072 lds
    v_mfma_f32_16x16x32_bf16 v[108:111], a[172:175], v[216:219], v[108:111]
    ds_read_b128 a[140:143], v30 offset:6144
    s_addk_i32 m0, 0x4000
    v_mfma_f32_16x16x32_bf16 v[140:143], a[172:175], v[220:223], v[140:143]
    ds_read_b128 a[144:147], v30 offset:8192
    s_add_u32 s48, s48, s49
    v_mfma_f32_16x16x32_bf16 v[112:115], a[176:179], v[216:219], v[112:115]
    ds_read_b128 a[148:151], v30 offset:10240
    ds_read_u16_d16_hi v59, v46 offset:384
    v_mfma_f32_16x16x32_bf16 v[144:147], a[176:179], v[220:223], v[144:147]
    buffer_load_dwordx4 v17, s[60:63], s48 offen lds
    v_mfma_f32_16x16x32_bf16 v[116:119], a[180:183], v[216:219], v[116:119]
    ds_read_b128 a[152:155], v30 offset:12288
    ds_read_u16_d16_hi v60, v47 offset:0
    v_mfma_f32_16x16x32_bf16 v[148:151], a[180:183], v[220:223], v[148:151]
    ds_read_b128 a[156:159], v30 offset:14336
    ds_read_u16_d16_hi v61, v47 offset:128
    v_mfma_f32_16x16x32_bf16 v[120:123], a[184:187], v[216:219], v[120:123]
    ds_read_b128 a[96:99], v34 offset:0
    ds_read_u16_d16_hi v62, v48 offset:256
    v_mfma_f32_16x16x32_bf16 v[152:155], a[184:187], v[220:223], v[152:155]
    buffer_load_dwordx4 v18, s[60:63], s48 offen offset:1024 lds
    v_mfma_f32_16x16x32_bf16 v[124:127], a[188:191], v[216:219], v[124:127]
    ds_read_b128 a[160:163], v31 offset:0
    ds_read_u16_d16_hi v63, v48 offset:384
    v_mfma_f32_16x16x32_bf16 v[156:159], a[188:191], v[220:223], v[156:159]
    ds_read_b128 a[164:167], v31 offset:2048
    s_waitcnt lgkmcnt(12)
    v_mfma_f32_16x16x32_bf16 v[96:99], a[128:131], v[208:211], v[96:99]
    ds_read_b128 a[168:171], v31 offset:4096
    ds_read_u16_d16_hi v64, v49 offset:0
    v_mfma_f32_16x16x32_bf16 v[128:131], a[128:131], v[212:215], v[128:131]
    buffer_load_dwordx4 v17, s[64:67], s48 offen offset:2048 lds
    v_mfma_f32_16x16x32_bf16 v[100:103], a[132:135], v[208:211], v[100:103]
    ds_read_b128 a[172:175], v31 offset:6144
    ds_read_u16_d16_hi v65, v49 offset:128
    v_mfma_f32_16x16x32_bf16 v[132:135], a[132:135], v[212:215], v[132:135]
    ds_read_b128 a[176:179], v31 offset:8192
    ds_read_u16_d16_hi v66, v50 offset:256
    v_mfma_f32_16x16x32_bf16 v[104:107], a[136:139], v[208:211], v[104:107]
    ds_read_b128 a[180:183], v31 offset:10240
    ds_read_u16_d16_hi v67, v50 offset:384
    v_mfma_f32_16x16x32_bf16 v[136:139], a[136:139], v[212:215], v[136:139]
    buffer_load_dwordx4 v18, s[64:67], s48 offen offset:3072 lds
    v_mfma_f32_16x16x32_bf16 v[108:111], a[140:143], v[208:211], v[108:111]
    ds_read_b128 a[184:187], v31 offset:12288
    s_addk_i32 m0, 0x4000
    v_mfma_f32_16x16x32_bf16 v[140:143], a[140:143], v[212:215], v[140:143]
    ds_read_b128 a[188:191], v31 offset:14336
    s_waitcnt lgkmcnt(15)
    v_mfma_f32_16x16x32_bf16 v[112:115], a[144:147], v[208:211], v[112:115]
    ds_read_b128 v[216:219], v39 offset:16384
    s_addk_i32 s45, 0x80
    v_mfma_f32_16x16x32_bf16 v[144:147], a[144:147], v[212:215], v[144:147]
    buffer_load_dwordx4 v11, s[56:59], s45 offen lds
    v_mfma_f32_16x16x32_bf16 v[116:119], a[148:151], v[208:211], v[116:119]
    ds_read_b128 v[220:223], v39 offset:18432
    ds_read_u16_d16_hi v68, v51 offset:0
    v_mfma_f32_16x16x32_bf16 v[148:151], a[148:151], v[212:215], v[148:151]
    ds_read_b128 a[100:103], v35 offset:0
    ds_read_u16_d16_hi v69, v51 offset:128
    v_mfma_f32_16x16x32_bf16 v[120:123], a[152:155], v[208:211], v[120:123]
    v_mfma_f32_16x16x32_bf16 v[152:155], a[152:155], v[212:215], v[152:155]
    buffer_load_dwordx4 v16, s[56:59], s45 offen offset:1024 lds
    v_mfma_f32_16x16x32_bf16 v[124:127], a[156:159], v[208:211], v[124:127]
    v_mfma_f32_16x16x32_bf16 v[156:159], a[156:159], v[212:215], v[156:159]
    s_waitcnt vmcnt(10) lgkmcnt(0)
    s_barrier
    v_mfma_f32_16x16x32_bf16 v[96:99], a[160:163], v[216:219], v[96:99]
    ds_read_b128 v[208:211], v38 offset:49152
    ds_read_b128 v[212:215], v38 offset:51200
    v_mfma_f32_16x16x32_bf16 v[128:131], a[160:163], v[220:223], v[128:131]
    buffer_load_dwordx4 v11, s[56:59], s45 offen offset:2048 lds
    v_mfma_f32_16x16x32_bf16 v[100:103], a[164:167], v[216:219], v[100:103]
    ds_read_b128 a[128:131], v30 offset:32768
    ds_read_u16_d16_hi v70, v52 offset:256
    v_mfma_f32_16x16x32_bf16 v[132:135], a[164:167], v[220:223], v[132:135]
    ds_read_b128 a[132:135], v30 offset:34816
    ds_read_u16_d16_hi v71, v52 offset:384
    v_mfma_f32_16x16x32_bf16 v[104:107], a[168:171], v[216:219], v[104:107]
    ds_read_b128 a[136:139], v30 offset:36864
    v_mfma_f32_16x16x32_bf16 v[136:139], a[168:171], v[220:223], v[136:139]
    buffer_load_dwordx4 v16, s[56:59], s45 offen offset:3072 lds
    v_mfma_f32_16x16x32_bf16 v[108:111], a[172:175], v[216:219], v[108:111]
    ds_read_b128 a[140:143], v30 offset:38912
    s_addk_i32 m0, 0x4000
    v_mfma_f32_16x16x32_bf16 v[140:143], a[172:175], v[220:223], v[140:143]
    ds_read_b128 a[144:147], v30 offset:40960
    s_add_u32 s48, s48, s49
    v_mfma_f32_16x16x32_bf16 v[112:115], a[176:179], v[216:219], v[112:115]
    ds_read_b128 a[148:151], v30 offset:43008
    v_mfma_f32_16x16x32_bf16 v[144:147], a[176:179], v[220:223], v[144:147]
    buffer_load_dwordx4 v17, s[60:63], s48 offen lds
    v_mfma_f32_16x16x32_bf16 v[116:119], a[180:183], v[216:219], v[116:119]
    ds_read_b128 a[152:155], v30 offset:45056
    v_mfma_f32_16x16x32_bf16 v[148:151], a[180:183], v[220:223], v[148:151]
    ds_read_b128 a[156:159], v30 offset:47104
    v_mfma_f32_16x16x32_bf16 v[120:123], a[184:187], v[216:219], v[120:123]
    ds_read_b128 a[104:107], v34 offset:32768
    v_mfma_f32_16x16x32_bf16 v[152:155], a[184:187], v[220:223], v[152:155]
    buffer_load_dwordx4 v18, s[60:63], s48 offen offset:1024 lds
    v_mfma_f32_16x16x32_bf16 v[124:127], a[188:191], v[216:219], v[124:127]
    ds_read_b128 a[160:163], v31 offset:32768
    v_mfma_f32_16x16x32_bf16 v[156:159], a[188:191], v[220:223], v[156:159]
    ds_read_b128 a[164:167], v31 offset:34816
    s_waitcnt lgkmcnt(7)
    v_mfma_f32_16x16x32_bf16 v[96:99], a[128:131], v[208:211], v[96:99]
    ds_read_b128 a[168:171], v31 offset:36864
    v_mfma_f32_16x16x32_bf16 v[128:131], a[128:131], v[212:215], v[128:131]
    buffer_load_dwordx4 v17, s[64:67], s48 offen offset:2048 lds
    v_mfma_f32_16x16x32_bf16 v[100:103], a[132:135], v[208:211], v[100:103]
    ds_read_b128 a[172:175], v31 offset:38912
    v_mfma_f32_16x16x32_bf16 v[132:135], a[132:135], v[212:215], v[132:135]
    ds_read_b128 a[176:179], v31 offset:40960
    v_mfma_f32_16x16x32_bf16 v[104:107], a[136:139], v[208:211], v[104:107]
    ds_read_b128 a[180:183], v31 offset:43008
    v_mfma_f32_16x16x32_bf16 v[136:139], a[136:139], v[212:215], v[136:139]
    buffer_load_dwordx4 v18, s[64:67], s48 offen offset:3072 lds
    v_mfma_f32_16x16x32_bf16 v[108:111], a[140:143], v[208:211], v[108:111]
    ds_read_b128 a[184:187], v31 offset:45056
    s_add_u32 m0, s47, 0x0
    v_mfma_f32_16x16x32_bf16 v[140:143], a[140:143], v[212:215], v[140:143]
    ds_read_b128 a[188:191], v31 offset:47104
    s_waitcnt lgkmcnt(9)
    v_mfma_f32_16x16x32_bf16 v[112:115], a[144:147], v[208:211], v[112:115]
    ds_read_b128 v[216:219], v39 offset:49152
    s_add_u32 s53, s22, 0x0
    v_mfma_f32_16x16x32_bf16 v[144:147], a[144:147], v[212:215], v[144:147]
    buffer_load_dwordx4 v19, s[88:91], s53 offen lds
    v_mfma_f32_16x16x32_bf16 v[116:119], a[148:151], v[208:211], v[116:119]
    ds_read_b128 v[220:223], v39 offset:51200
    v_mfma_f32_16x16x32_bf16 v[148:151], a[148:151], v[212:215], v[148:151]
    ds_read_b128 a[108:111], v35 offset:32768
    v_mfma_f32_16x16x32_bf16 v[120:123], a[152:155], v[208:211], v[120:123]
    v_mfma_f32_16x16x32_bf16 v[152:155], a[152:155], v[212:215], v[152:155]
    buffer_load_dwordx4 v20, s[88:91], s53 offen offset:1024 lds
    v_mfma_f32_16x16x32_bf16 v[124:127], a[156:159], v[208:211], v[124:127]
    v_mfma_f32_16x16x32_bf16 v[156:159], a[156:159], v[212:215], v[156:159]
    s_waitcnt vmcnt(10) lgkmcnt(0)
    s_barrier
    v_mfma_f32_16x16x32_bf16 v[96:99], a[160:163], v[216:219], v[96:99]
    ds_read_b128 v[208:211], v40 offset:16384
    ds_read_b128 v[212:215], v40 offset:18432
    v_mfma_f32_16x16x32_bf16 v[128:131], a[160:163], v[220:223], v[128:131]
    buffer_load_dwordx4 v19, s[8:11], s53 offen offset:2048 lds
    v_mfma_f32_16x16x32_bf16 v[100:103], a[164:167], v[216:219], v[100:103]
    ds_read_b128 a[128:131], v32 offset:0
    v_mfma_f32_16x16x32_bf16 v[132:135], a[164:167], v[220:223], v[132:135]
    ds_read_b128 a[132:135], v32 offset:2048
    v_mfma_f32_16x16x32_bf16 v[104:107], a[168:171], v[216:219], v[104:107]
    ds_read_b128 a[136:139], v32 offset:4096
    v_mfma_f32_16x16x32_bf16 v[136:139], a[168:171], v[220:223], v[136:139]
    buffer_load_dwordx4 v20, s[8:11], s53 offen offset:3072 lds
    v_mfma_f32_16x16x32_bf16 v[108:111], a[172:175], v[216:219], v[108:111]
    ds_read_b128 a[140:143], v32 offset:6144
    s_add_u32 m0, s47, 0x4000
    v_mfma_f32_16x16x32_bf16 v[140:143], a[172:175], v[220:223], v[140:143]
    ds_read_b128 a[144:147], v32 offset:8192
    s_add_u32 s53, s22, 0x80
    v_mfma_f32_16x16x32_bf16 v[112:115], a[176:179], v[216:219], v[112:115]
    ds_read_b128 a[148:151], v32 offset:10240
    v_mfma_f32_16x16x32_bf16 v[144:147], a[176:179], v[220:223], v[144:147]
    buffer_load_dwordx4 v19, s[88:91], s53 offen lds
    v_mfma_f32_16x16x32_bf16 v[116:119], a[180:183], v[216:219], v[116:119]
    ds_read_b128 a[152:155], v32 offset:12288
    v_mfma_f32_16x16x32_bf16 v[148:151], a[180:183], v[220:223], v[148:151]
    ds_read_b128 a[156:159], v32 offset:14336
    v_mfma_f32_16x16x32_bf16 v[120:123], a[184:187], v[216:219], v[120:123]
    ds_read_b128 a[112:115], v36 offset:0
    v_mfma_f32_16x16x32_bf16 v[152:155], a[184:187], v[220:223], v[152:155]
    buffer_load_dwordx4 v20, s[88:91], s53 offen offset:1024 lds
    v_mfma_f32_16x16x32_bf16 v[124:127], a[188:191], v[216:219], v[124:127]
    ds_read_b128 a[160:163], v33 offset:0
    v_mfma_f32_16x16x32_bf16 v[156:159], a[188:191], v[220:223], v[156:159]
    ds_read_b128 a[164:167], v33 offset:2048
    s_waitcnt lgkmcnt(7)
    v_mfma_f32_16x16x32_bf16 v[96:99], a[128:131], v[208:211], v[96:99]
    ds_read_b128 a[168:171], v33 offset:4096
    v_mfma_f32_16x16x32_bf16 v[128:131], a[128:131], v[212:215], v[128:131]
    buffer_load_dwordx4 v19, s[8:11], s53 offen offset:2048 lds
    v_mfma_f32_16x16x32_bf16 v[100:103], a[132:135], v[208:211], v[100:103]
    ds_read_b128 a[172:175], v33 offset:6144
    v_mfma_f32_16x16x32_bf16 v[132:135], a[132:135], v[212:215], v[132:135]
    ds_read_b128 a[176:179], v33 offset:8192
    v_mfma_f32_16x16x32_bf16 v[104:107], a[136:139], v[208:211], v[104:107]
    ds_read_b128 a[180:183], v33 offset:10240
    v_mfma_f32_16x16x32_bf16 v[136:139], a[136:139], v[212:215], v[136:139]
    buffer_load_dwordx4 v20, s[8:11], s53 offen offset:3072 lds
    v_mfma_f32_16x16x32_bf16 v[108:111], a[140:143], v[208:211], v[108:111]
    ds_read_b128 a[184:187], v33 offset:12288
    s_add_u32 m0, s47, 0x8000
    v_mfma_f32_16x16x32_bf16 v[140:143], a[140:143], v[212:215], v[140:143]
    ds_read_b128 a[188:191], v33 offset:14336
    s_waitcnt lgkmcnt(9)
    v_mfma_f32_16x16x32_bf16 v[112:115], a[144:147], v[208:211], v[112:115]
    ds_read_b128 v[216:219], v41 offset:16384
    s_add_u32 s53, s22, 0x100
    v_mfma_f32_16x16x32_bf16 v[144:147], a[144:147], v[212:215], v[144:147]
    buffer_load_dwordx4 v19, s[88:91], s53 offen lds
    v_mfma_f32_16x16x32_bf16 v[116:119], a[148:151], v[208:211], v[116:119]
    ds_read_b128 v[220:223], v41 offset:18432
    v_mfma_f32_16x16x32_bf16 v[148:151], a[148:151], v[212:215], v[148:151]
    ds_read_b128 a[116:119], v37 offset:0
    v_mfma_f32_16x16x32_bf16 v[120:123], a[152:155], v[208:211], v[120:123]
    v_mfma_f32_16x16x32_bf16 v[152:155], a[152:155], v[212:215], v[152:155]
    buffer_load_dwordx4 v20, s[88:91], s53 offen offset:1024 lds
    v_mfma_f32_16x16x32_bf16 v[124:127], a[156:159], v[208:211], v[124:127]
    v_mfma_f32_16x16x32_bf16 v[156:159], a[156:159], v[212:215], v[156:159]
    s_waitcnt vmcnt(10) lgkmcnt(0)
    s_barrier
    v_mfma_f32_16x16x32_bf16 v[96:99], a[160:163], v[216:219], v[96:99]
    ds_read_b128 v[208:211], v40 offset:49152
    ds_read_b128 v[212:215], v40 offset:51200
    v_mfma_f32_16x16x32_bf16 v[128:131], a[160:163], v[220:223], v[128:131]
    buffer_load_dwordx4 v19, s[8:11], s53 offen offset:2048 lds
    v_mfma_f32_16x16x32_bf16 v[100:103], a[164:167], v[216:219], v[100:103]
    ds_read_b128 a[128:131], v32 offset:32768
    v_mfma_f32_16x16x32_bf16 v[132:135], a[164:167], v[220:223], v[132:135]
    ds_read_b128 a[132:135], v32 offset:34816
    v_mfma_f32_16x16x32_bf16 v[104:107], a[168:171], v[216:219], v[104:107]
    ds_read_b128 a[136:139], v32 offset:36864
    v_mfma_f32_16x16x32_bf16 v[136:139], a[168:171], v[220:223], v[136:139]
    buffer_load_dwordx4 v20, s[8:11], s53 offen offset:3072 lds
    v_mfma_f32_16x16x32_bf16 v[108:111], a[172:175], v[216:219], v[108:111]
    ds_read_b128 a[140:143], v32 offset:38912
    s_add_u32 m0, s47, 0xc000
    v_mfma_f32_16x16x32_bf16 v[140:143], a[172:175], v[220:223], v[140:143]
    ds_read_b128 a[144:147], v32 offset:40960
    s_add_u32 s53, s22, 0x180
    v_mfma_f32_16x16x32_bf16 v[112:115], a[176:179], v[216:219], v[112:115]
    ds_read_b128 a[148:151], v32 offset:43008
    v_mfma_f32_16x16x32_bf16 v[144:147], a[176:179], v[220:223], v[144:147]
    buffer_load_dwordx4 v19, s[88:91], s53 offen lds
    v_mfma_f32_16x16x32_bf16 v[116:119], a[180:183], v[216:219], v[116:119]
    ds_read_b128 a[152:155], v32 offset:45056
    v_mfma_f32_16x16x32_bf16 v[148:151], a[180:183], v[220:223], v[148:151]
    ds_read_b128 a[156:159], v32 offset:47104
    v_mfma_f32_16x16x32_bf16 v[120:123], a[184:187], v[216:219], v[120:123]
    ds_read_b128 a[120:123], v36 offset:32768
    v_mfma_f32_16x16x32_bf16 v[152:155], a[184:187], v[220:223], v[152:155]
    buffer_load_dwordx4 v20, s[88:91], s53 offen offset:1024 lds
    v_mfma_f32_16x16x32_bf16 v[124:127], a[188:191], v[216:219], v[124:127]
    ds_read_b128 a[160:163], v33 offset:32768
    v_mfma_f32_16x16x32_bf16 v[156:159], a[188:191], v[220:223], v[156:159]
    ds_read_b128 a[164:167], v33 offset:34816
    s_waitcnt lgkmcnt(7)
    v_mfma_f32_16x16x32_bf16 v[96:99], a[128:131], v[208:211], v[96:99]
    ds_read_b128 a[168:171], v33 offset:36864
    v_mfma_f32_16x16x32_bf16 v[128:131], a[128:131], v[212:215], v[128:131]
    buffer_load_dwordx4 v19, s[8:11], s53 offen offset:2048 lds
    v_mfma_f32_16x16x32_bf16 v[100:103], a[132:135], v[208:211], v[100:103]
    ds_read_b128 a[172:175], v33 offset:38912
    v_mfma_f32_16x16x32_bf16 v[132:135], a[132:135], v[212:215], v[132:135]
    ds_read_b128 a[176:179], v33 offset:40960
    v_mfma_f32_16x16x32_bf16 v[104:107], a[136:139], v[208:211], v[104:107]
    ds_read_b128 a[180:183], v33 offset:43008
    v_mfma_f32_16x16x32_bf16 v[136:139], a[136:139], v[212:215], v[136:139]
    buffer_load_dwordx4 v20, s[8:11], s53 offen offset:3072 lds
    v_mfma_f32_16x16x32_bf16 v[108:111], a[140:143], v[208:211], v[108:111]
    ds_read_b128 a[184:187], v33 offset:45056
    s_add_u32 m0, s47, 0x10000
    v_mfma_f32_16x16x32_bf16 v[140:143], a[140:143], v[212:215], v[140:143]
    ds_read_b128 a[188:191], v33 offset:47104
    s_waitcnt lgkmcnt(9)
    v_mfma_f32_16x16x32_bf16 v[112:115], a[144:147], v[208:211], v[112:115]
    ds_read_b128 v[216:219], v41 offset:49152
    s_add_u32 s53, s22, 0x200
    v_mfma_f32_16x16x32_bf16 v[144:147], a[144:147], v[212:215], v[144:147]
    buffer_load_dwordx4 v19, s[88:91], s53 offen lds
    v_mfma_f32_16x16x32_bf16 v[116:119], a[148:151], v[208:211], v[116:119]
    ds_read_b128 v[220:223], v41 offset:51200
    v_mfma_f32_16x16x32_bf16 v[148:151], a[148:151], v[212:215], v[148:151]
    ds_read_b128 a[124:127], v37 offset:32768
    v_mfma_f32_16x16x32_bf16 v[120:123], a[152:155], v[208:211], v[120:123]
    v_mfma_f32_16x16x32_bf16 v[152:155], a[152:155], v[212:215], v[152:155]
    buffer_load_dwordx4 v20, s[88:91], s53 offen offset:1024 lds
    v_mfma_f32_16x16x32_bf16 v[124:127], a[156:159], v[208:211], v[124:127]
    v_mfma_f32_16x16x32_bf16 v[156:159], a[156:159], v[212:215], v[156:159]
    s_waitcnt vmcnt(10) lgkmcnt(0)
    s_barrier
    v_mfma_f32_16x16x32_bf16 v[96:99], a[160:163], v[216:219], v[96:99]
    v_mfma_f32_16x16x32_bf16 v[128:131], a[160:163], v[220:223], v[128:131]
    buffer_load_dwordx4 v19, s[8:11], s53 offen offset:2048 lds
    v_mfma_f32_16x16x32_bf16 v[100:103], a[164:167], v[216:219], v[100:103]
    v_mfma_f32_16x16x32_bf16 v[132:135], a[164:167], v[220:223], v[132:135]
    v_mfma_f32_16x16x32_bf16 v[104:107], a[168:171], v[216:219], v[104:107]
    s_nop 2
    v_fma_f32 v202, v164, v96, v98
    v_fma_f32 v203, v164, v97, v99
    v_mfma_f32_16x16x32_bf16 v[136:139], a[168:171], v[220:223], v[136:139]
    buffer_load_dwordx4 v20, s[8:11], s53 offen offset:3072 lds
    v_mfma_f32_16x16x32_bf16 v[108:111], a[172:175], v[216:219], v[108:111]
    v_fma_f32 v204, v164, v128, v130
    v_fma_f32 v205, v164, v129, v131
    s_add_u32 m0, s47, 0x14000
    v_mfma_f32_16x16x32_bf16 v[140:143], a[172:175], v[220:223], v[140:143]
    v_fma_f32 v202, -v165, v128, v202
    v_fma_f32 v203, -v165, v129, v203
    s_add_u32 s53, s22, 0x280
    v_mfma_f32_16x16x32_bf16 v[112:115], a[176:179], v[216:219], v[112:115]
    v_fma_f32 v204, v165, v96, v204
    v_fma_f32 v205, v165, v97, v205
    v_mfma_f32_16x16x32_bf16 v[144:147], a[176:179], v[220:223], v[144:147]
    buffer_load_dwordx4 v19, s[88:91], s53 offen lds
    v_mfma_f32_16x16x32_bf16 v[116:119], a[180:183], v[216:219], v[116:119]
    v_fma_f32 v198, v164, v202, v100
    v_fma_f32 v199, v164, v203, v101
    v_mfma_f32_16x16x32_bf16 v[148:151], a[180:183], v[220:223], v[148:151]
    v_fma_f32 v200, v164, v204, v132
    v_fma_f32 v201, v164, v205, v133
    v_mfma_f32_16x16x32_bf16 v[120:123], a[184:187], v[216:219], v[120:123]
    v_fma_f32 v198, -v165, v204, v198
    v_fma_f32 v199, -v165, v205, v199
    v_mfma_f32_16x16x32_bf16 v[152:155], a[184:187], v[220:223], v[152:155]
    buffer_load_dwordx4 v20, s[88:91], s53 offen offset:1024 lds
    v_mfma_f32_16x16x32_bf16 v[124:127], a[188:191], v[216:219], v[124:127]
    v_fma_f32 v200, v165, v202, v200
    v_fma_f32 v201, v165, v203, v201
    v_mfma_f32_16x16x32_bf16 v[156:159], a[188:191], v[220:223], v[156:159]
    v_fma_f32 v202, v164, v198, v102
    v_fma_f32 v203, v164, v199, v103
    v_pk_fma_f32 v[204:205], v[164:165], v[200:201], v[134:135] op_sel_hi:[0,1,1]
    v_pk_fma_f32 v[202:203], v[164:165], v[200:201], v[202:203] op_sel:[1,0,0] neg_lo:[1,0,0] neg_hi:[1,0,0]
    v_pk_fma_f32 v[204:205], v[164:165], v[198:199], v[204:205] op_sel:[1,0,0]
    v_pk_fma_f32 v[198:199], v[164:165], v[202:203], v[104:105] op_sel_hi:[0,1,1]
    v_pk_fma_f32 v[200:201], v[164:165], v[204:205], v[136:137] op_sel_hi:[0,1,1]
    v_pk_fma_f32 v[198:199], v[164:165], v[204:205], v[198:199] op_sel:[1,0,0] neg_lo:[1,0,0] neg_hi:[1,0,0]
    v_pk_fma_f32 v[200:201], v[164:165], v[202:203], v[200:201] op_sel:[1,0,0]
    v_pk_fma_f32 v[202:203], v[164:165], v[198:199], v[106:107] op_sel_hi:[0,1,1]
    v_pk_fma_f32 v[204:205], v[164:165], v[200:201], v[138:139] op_sel_hi:[0,1,1]
    v_pk_fma_f32 v[202:203], v[164:165], v[200:201], v[202:203] op_sel:[1,0,0] neg_lo:[1,0,0] neg_hi:[1,0,0]
    v_pk_fma_f32 v[204:205], v[164:165], v[198:199], v[204:205] op_sel:[1,0,0]
    v_pk_fma_f32 v[198:199], v[164:165], v[202:203], v[108:109] op_sel_hi:[0,1,1]
    v_pk_fma_f32 v[200:201], v[164:165], v[204:205], v[140:141] op_sel_hi:[0,1,1]
    v_pk_fma_f32 v[198:199], v[164:165], v[204:205], v[198:199] op_sel:[1,0,0] neg_lo:[1,0,0] neg_hi:[1,0,0]
    v_pk_fma_f32 v[200:201], v[164:165], v[202:203], v[200:201] op_sel:[1,0,0]
    v_pk_fma_f32 v[202:203], v[164:165], v[198:199], v[110:111] op_sel_hi:[0,1,1]
    v_pk_fma_f32 v[204:205], v[164:165], v[200:201], v[142:143] op_sel_hi:[0,1,1]
    v_pk_fma_f32 v[202:203], v[164:165], v[200:201], v[202:203] op_sel:[1,0,0] neg_lo:[1,0,0] neg_hi:[1,0,0]
    v_pk_fma_f32 v[204:205], v[164:165], v[198:199], v[204:205] op_sel:[1,0,0]
    v_pk_fma_f32 v[198:199], v[164:165], v[202:203], v[112:113] op_sel_hi:[0,1,1]
    v_pk_fma_f32 v[200:201], v[164:165], v[204:205], v[144:145] op_sel_hi:[0,1,1]
    v_pk_fma_f32 v[198:199], v[164:165], v[204:205], v[198:199] op_sel:[1,0,0] neg_lo:[1,0,0] neg_hi:[1,0,0]
    v_pk_fma_f32 v[200:201], v[164:165], v[202:203], v[200:201] op_sel:[1,0,0]
    v_pk_fma_f32 v[202:203], v[164:165], v[198:199], v[114:115] op_sel_hi:[0,1,1]
    v_pk_fma_f32 v[204:205], v[164:165], v[200:201], v[146:147] op_sel_hi:[0,1,1]
    v_pk_fma_f32 v[202:203], v[164:165], v[200:201], v[202:203] op_sel:[1,0,0] neg_lo:[1,0,0] neg_hi:[1,0,0]
    v_pk_fma_f32 v[204:205], v[164:165], v[198:199], v[204:205] op_sel:[1,0,0]
    v_pk_fma_f32 v[198:199], v[164:165], v[202:203], v[116:117] op_sel_hi:[0,1,1]
    v_pk_fma_f32 v[200:201], v[164:165], v[204:205], v[148:149] op_sel_hi:[0,1,1]
    v_pk_fma_f32 v[198:199], v[164:165], v[204:205], v[198:199] op_sel:[1,0,0] neg_lo:[1,0,0] neg_hi:[1,0,0]
    v_pk_fma_f32 v[200:201], v[164:165], v[202:203], v[200:201] op_sel:[1,0,0]
    v_pk_fma_f32 v[202:203], v[164:165], v[198:199], v[118:119] op_sel_hi:[0,1,1]
    v_pk_fma_f32 v[204:205], v[164:165], v[200:201], v[150:151] op_sel_hi:[0,1,1]
    v_pk_fma_f32 v[202:203], v[164:165], v[200:201], v[202:203] op_sel:[1,0,0] neg_lo:[1,0,0] neg_hi:[1,0,0]
    v_pk_fma_f32 v[204:205], v[164:165], v[198:199], v[204:205] op_sel:[1,0,0]
    v_pk_fma_f32 v[198:199], v[164:165], v[202:203], v[120:121] op_sel_hi:[0,1,1]
    v_pk_fma_f32 v[200:201], v[164:165], v[204:205], v[152:153] op_sel_hi:[0,1,1]
    v_pk_fma_f32 v[198:199], v[164:165], v[204:205], v[198:199] op_sel:[1,0,0] neg_lo:[1,0,0] neg_hi:[1,0,0]
    v_pk_fma_f32 v[200:201], v[164:165], v[202:203], v[200:201] op_sel:[1,0,0]
    v_pk_fma_f32 v[202:203], v[164:165], v[198:199], v[122:123] op_sel_hi:[0,1,1]
    v_pk_fma_f32 v[204:205], v[164:165], v[200:201], v[154:155] op_sel_hi:[0,1,1]
    v_pk_fma_f32 v[202:203], v[164:165], v[200:201], v[202:203] op_sel:[1,0,0] neg_lo:[1,0,0] neg_hi:[1,0,0]
    v_pk_fma_f32 v[204:205], v[164:165], v[198:199], v[204:205] op_sel:[1,0,0]
    v_pk_fma_f32 v[198:199], v[164:165], v[202:203], v[124:125] op_sel_hi:[0,1,1]
    v_pk_fma_f32 v[200:201], v[164:165], v[204:205], v[156:157] op_sel_hi:[0,1,1]
    v_pk_fma_f32 v[198:199], v[164:165], v[204:205], v[198:199] op_sel:[1,0,0] neg_lo:[1,0,0] neg_hi:[1,0,0]
    v_pk_fma_f32 v[200:201], v[164:165], v[202:203], v[200:201] op_sel:[1,0,0]
    v_pk_fma_f32 v[202:203], v[164:165], v[198:199], v[126:127] op_sel_hi:[0,1,1]
    v_pk_fma_f32 v[204:205], v[164:165], v[200:201], v[158:159] op_sel_hi:[0,1,1]
    v_pk_fma_f32 v[202:203], v[164:165], v[200:201], v[202:203] op_sel:[1,0,0] neg_lo:[1,0,0] neg_hi:[1,0,0]
    v_pk_fma_f32 v[204:205], v[164:165], v[198:199], v[204:205] op_sel:[1,0,0]
    v_fma_f32 v8, v166, v202, v203
    v_fma_f32 v9, v166, v204, v205
    v_fma_f32 v8, -v167, v204, v8
    v_fmac_f32 v9, v167, v202
    v_mov_b32 v12, v8
    v_mov_b32 v13, v9
    s_nop 0
    v_permlane16_swap_b32 v8, v12
    v_permlane16_swap_b32 v9, v13
    v_mov_b32 v14, v8
    v_mov_b32 v22, v12
    v_mov_b32 v15, v9
    v_mov_b32 v23, v13
    v_permlane32_swap_b32 v8, v14
    v_permlane32_swap_b32 v12, v22
    v_permlane32_swap_b32 v9, v15
    v_permlane32_swap_b32 v13, v23
    v_pk_fma_f32 v[12:13], v[168:169], v[8:9], v[12:13] op_sel_hi:[0,1,1]
    v_pk_fma_f32 v[12:13], v[168:169], v[8:9], v[12:13] op_sel:[1,1,0] op_sel_hi:[1,0,1] neg_lo:[1,0,0]
    v_pk_fma_f32 v[14:15], v[168:169], v[12:13], v[14:15] op_sel_hi:[0,1,1]
    v_pk_fma_f32 v[14:15], v[168:169], v[12:13], v[14:15] op_sel:[1,1,0] op_sel_hi:[1,0,1] neg_lo:[1,0,0]
    v_pk_fma_f32 v[24:25], v[168:169], v[14:15], v[22:23] op_sel_hi:[0,1,1]
    v_pk_fma_f32 v[24:25], v[168:169], v[14:15], v[24:25] op_sel:[1,1,0] op_sel_hi:[1,0,1] neg_lo:[1,0,0]
    v_perm_b32 v24, v24, v190, s19
    v_perm_b32 v25, v25, v190, s34
    s_mov_b64 exec, 0xffff
    buffer_store_dwordx2 v[24:25], v189, s[80:83], 0 offen sc1
    s_mov_b64 exec, -1
    s_branch LY_pg0
.p2align 12
LY_pg0:
    s_movk_i32 s19, 0xff00
    v_cndmask_b32_e64 v30, 0, v8, s[24:25]
    v_cndmask_b32_e64 v30, v30, v12, s[26:27]
    v_cndmask_b32_e64 v30, v30, v14, s[28:29]
    v_cndmask_b32_e64 v31, 0, v9, s[24:25]
    v_cndmask_b32_e64 v31, v31, v13, s[26:27]
    v_cndmask_b32_e64 v31, v31, v15, s[28:29]
    v_fma_f32 v32, v166, v30, v202
    v_fma_f32 v33, v166, v31, v204
    buffer_load_dwordx4 v19, s[8:11], s53 offen offset:2048 lds
    v_fma_f32 v32, -v167, v31, v32
    v_fmac_f32 v33, v167, v30
    v_mul_f32 v34, v174, v30
    v_mul_f32 v36, v174, v31
    v_fma_f32 v34, -v175, v31, v34
    v_fmac_f32 v36, v175, v30
    v_mul_f32 v35, v174, v32
    v_mul_f32 v37, v174, v33
    v_fma_f32 v35, -v175, v33, v35
    buffer_load_dwordx4 v20, s[8:11], s53 offen offset:3072 lds
    v_fmac_f32 v37, v175, v32
    v_pk_mul_f32 v[208:209], v[174:175], v[96:97] op_sel_hi:[0,1]
    v_pk_fma_f32 v[208:209], v[174:175], v[128:129], v[208:209] op_sel:[1,0,0] neg_lo:[1,0,0] neg_hi:[1,0,0]
    v_pk_mul_f32 v[128:129], v[174:175], v[128:129] op_sel_hi:[0,1] neg_lo:[1,0] neg_hi:[1,0]
    v_pk_fma_f32 v[128:129], v[174:175], v[96:97], v[128:129] op_sel:[1,0,0] neg_lo:[1,0,0] neg_hi:[1,0,0]
    v_pk_mul_f32 v[210:211], v[174:175], v[98:99] op_sel_hi:[0,1]
    v_pk_fma_f32 v[210:211], v[174:175], v[130:131], v[210:211] op_sel:[1,0,0] neg_lo:[1,0,0] neg_hi:[1,0,0]
    v_pk_mul_f32 v[130:131], v[174:175], v[130:131] op_sel_hi:[0,1] neg_lo:[1,0] neg_hi:[1,0]
    v_pk_fma_f32 v[130:131], v[174:175], v[98:99], v[130:131] op_sel:[1,0,0] neg_lo:[1,0,0] neg_hi:[1,0,0]
    s_add_u32 m0, s47, 0x18000
    s_add_u32 s53, s22, 0x300
    buffer_load_dwordx4 v19, s[88:91], s53 offen lds
    v_pk_mul_f32 v[212:213], v[174:175], v[100:101] op_sel_hi:[0,1]
    v_pk_fma_f32 v[212:213], v[174:175], v[132:133], v[212:213] op_sel:[1,0,0] neg_lo:[1,0,0] neg_hi:[1,0,0]
    v_pk_mul_f32 v[132:133], v[174:175], v[132:133] op_sel_hi:[0,1] neg_lo:[1,0] neg_hi:[1,0]
    v_pk_fma_f32 v[132:133], v[174:175], v[100:101], v[132:133] op_sel:[1,0,0] neg_lo:[1,0,0] neg_hi:[1,0,0]
    v_pk_mul_f32 v[214:215], v[174:175], v[102:103] op_sel_hi:[0,1]
    v_pk_fma_f32 v[214:215], v[174:175], v[134:135], v[214:215] op_sel:[1,0,0] neg_lo:[1,0,0] neg_hi:[1,0,0]
    v_pk_mul_f32 v[134:135], v[174:175], v[134:135] op_sel_hi:[0,1] neg_lo:[1,0] neg_hi:[1,0]
    v_pk_fma_f32 v[134:135], v[174:175], v[102:103], v[134:135] op_sel:[1,0,0] neg_lo:[1,0,0] neg_hi:[1,0,0]
    v_pk_mul_f32 v[216:217], v[174:175], v[104:105] op_sel_hi:[0,1]
    buffer_load_dwordx4 v20, s[88:91], s53 offen offset:1024 lds
    v_pk_fma_f32 v[216:217], v[174:175], v[136:137], v[216:217] op_sel:[1,0,0] neg_lo:[1,0,0] neg_hi:[1,0,0]
    v_pk_mul_f32 v[136:137], v[174:175], v[136:137] op_sel_hi:[0,1] neg_lo:[1,0] neg_hi:[1,0]
    v_pk_fma_f32 v[136:137], v[174:175], v[104:105], v[136:137] op_sel:[1,0,0] neg_lo:[1,0,0] neg_hi:[1,0,0]
    v_pk_mul_f32 v[218:219], v[174:175], v[106:107] op_sel_hi:[0,1]
    v_pk_fma_f32 v[218:219], v[174:175], v[138:139], v[218:219] op_sel:[1,0,0] neg_lo:[1,0,0] neg_hi:[1,0,0]
    v_pk_mul_f32 v[138:139], v[174:175], v[138:139] op_sel_hi:[0,1] neg_lo:[1,0] neg_hi:[1,0]
    v_pk_fma_f32 v[138:139], v[174:175], v[106:107], v[138:139] op_sel:[1,0,0] neg_lo:[1,0,0] neg_hi:[1,0,0]
    v_pk_mul_f32 v[220:221], v[174:175], v[108:109] op_sel_hi:[0,1]
    v_pk_fma_f32 v[220:221], v[174:175], v[140:141], v[220:221] op_sel:[1,0,0] neg_lo:[1,0,0] neg_hi:[1,0,0]
    buffer_load_dwordx4 v19, s[8:11], s53 offen offset:2048 lds
    v_pk_mul_f32 v[140:141], v[174:175], v[140:141] op_sel_hi:[0,1] neg_lo:[1,0] neg_hi:[1,0]
    v_pk_fma_f32 v[140:141], v[174:175], v[108:109], v[140:141] op_sel:[1,0,0] neg_lo:[1,0,0] neg_hi:[1,0,0]
    v_pk_mul_f32 v[222:223], v[174:175], v[110:111] op_sel_hi:[0,1]
    buffer_load_dwordx2 v[42:43], v95, s[80:83], 0 offen sc1
    buffer_load_dwordx2 v[46:47], v186, s[80:83], 0 offen sc1
    buffer_load_dwordx2 v[48:49], v187, s[80:83], 0 offen sc1
    buffer_load_dwordx2 v[50:51], v188, s[80:83], 0 offen sc1
    buffer_load_dwordx4 v20, s[8:11], s53 offen offset:3072 lds
    v_pk_fma_f32 v[222:223], v[174:175], v[142:143], v[222:223] op_sel:[1,0,0] neg_lo:[1,0,0] neg_hi:[1,0,0]
    v_pk_mul_f32 v[142:143], v[174:175], v[142:143] op_sel_hi:[0,1] neg_lo:[1,0] neg_hi:[1,0]
    v_pk_fma_f32 v[142:143], v[174:175], v[110:111], v[142:143] op_sel:[1,0,0] neg_lo:[1,0,0] neg_hi:[1,0,0]
    v_pk_mul_f32 v[224:225], v[174:175], v[112:113] op_sel_hi:[0,1]
    v_pk_fma_f32 v[224:225], v[174:175], v[144:145], v[224:225] op_sel:[1,0,0] neg_lo:[1,0,0] neg_hi:[1,0,0]
    v_pk_mul_f32 v[144:145], v[174:175], v[144:145] op_sel_hi:[0,1] neg_lo:[1,0] neg_hi:[1,0]
    v_pk_fma_f32 v[144:145], v[174:175], v[112:113], v[144:145] op_sel:[1,0,0] neg_lo:[1,0,0] neg_hi:[1,0,0]
    v_pk_mul_f32 v[226:227], v[174:175], v[114:115] op_sel_hi:[0,1]
    v_pk_fma_f32 v[226:227], v[174:175], v[146:147], v[226:227] op_sel:[1,0,0] neg_lo:[1,0,0] neg_hi:[1,0,0]
    v_pk_mul_f32 v[146:147], v[174:175], v[146:147] op_sel_hi:[0,1] neg_lo:[1,0] neg_hi:[1,0]
    s_add_u32 m0, s47, 0x1c000
    s_add_u32 s53, s22, 0x380
    buffer_load_dwordx4 v19, s[88:91], s53 offen lds
    v_pk_fma_f32 v[146:147], v[174:175], v[114:115], v[146:147] op_sel:[1,0,0] neg_lo:[1,0,0] neg_hi:[1,0,0]
    v_pk_mul_f32 v[228:229], v[174:175], v[116:117] op_sel_hi:[0,1]
    v_pk_fma_f32 v[228:229], v[174:175], v[148:149], v[228:229] op_sel:[1,0,0] neg_lo:[1,0,0] neg_hi:[1,0,0]
    v_pk_mul_f32 v[148:149], v[174:175], v[148:149] op_sel_hi:[0,1] neg_lo:[1,0] neg_hi:[1,0]
    v_pk_fma_f32 v[148:149], v[174:175], v[116:117], v[148:149] op_sel:[1,0,0] neg_lo:[1,0,0] neg_hi:[1,0,0]
    v_pk_mul_f32 v[230:231], v[174:175], v[118:119] op_sel_hi:[0,1]
    v_pk_fma_f32 v[230:231], v[174:175], v[150:151], v[230:231] op_sel:[1,0,0] neg_lo:[1,0,0] neg_hi:[1,0,0]
    v_pk_mul_f32 v[150:151], v[174:175], v[150:151] op_sel_hi:[0,1] neg_lo:[1,0] neg_hi:[1,0]
    v_pk_fma_f32 v[150:151], v[174:175], v[118:119], v[150:151] op_sel:[1,0,0] neg_lo:[1,0,0] neg_hi:[1,0,0]
    v_pk_mul_f32 v[232:233], v[174:175], v[120:121] op_sel_hi:[0,1]
    buffer_load_dwordx4 v20, s[88:91], s53 offen offset:1024 lds
    v_pk_fma_f32 v[232:233], v[174:175], v[152:153], v[232:233] op_sel:[1,0,0] neg_lo:[1,0,0] neg_hi:[1,0,0]
    v_pk_mul_f32 v[152:153], v[174:175], v[152:153] op_sel_hi:[0,1] neg_lo:[1,0] neg_hi:[1,0]
    v_pk_fma_f32 v[152:153], v[174:175], v[120:121], v[152:153] op_sel:[1,0,0] neg_lo:[1,0,0] neg_hi:[1,0,0]
    v_pk_mul_f32 v[234:235], v[174:175], v[122:123] op_sel_hi:[0,1]
    v_pk_fma_f32 v[234:235], v[174:175], v[154:155], v[234:235] op_sel:[1,0,0] neg_lo:[1,0,0] neg_hi:[1,0,0]
    v_pk_mul_f32 v[154:155], v[174:175], v[154:155] op_sel_hi:[0,1] neg_lo:[1,0] neg_hi:[1,0]
    v_pk_fma_f32 v[154:155], v[174:175], v[122:123], v[154:155] op_sel:[1,0,0] neg_lo:[1,0,0] neg_hi:[1,0,0]
    v_pk_mul_f32 v[236:237], v[174:175], v[124:125] op_sel_hi:[0,1]
    v_pk_fma_f32 v[236:237], v[174:175], v[156:157], v[236:237] op_sel:[1,0,0] neg_lo:[1,0,0] neg_hi:[1,0,0]
    v_pk_mul_f32 v[156:157], v[174:175], v[156:157] op_sel_hi:[0,1] neg_lo:[1,0] neg_hi:[1,0]
    buffer_load_dwordx4 v19, s[8:11], s53 offen offset:2048 lds
    v_pk_fma_f32 v[156:157], v[174:175], v[124:125], v[156:157] op_sel:[1,0,0] neg_lo:[1,0,0] neg_hi:[1,0,0]
    v_pk_mul_f32 v[238:239], v[174:175], v[126:127] op_sel_hi:[0,1]
    v_pk_fma_f32 v[238:239], v[174:175], v[158:159], v[238:239] op_sel:[1,0,0] neg_lo:[1,0,0] neg_hi:[1,0,0]
    v_pk_mul_f32 v[158:159], v[174:175], v[158:159] op_sel_hi:[0,1] neg_lo:[1,0] neg_hi:[1,0]
    v_pk_fma_f32 v[158:159], v[174:175], v[126:127], v[158:159] op_sel:[1,0,0] neg_lo:[1,0,0] neg_hi:[1,0,0]
    v_mfma_f32_16x16x32_bf16 v[160:163], a[64:67], a[0:3], 0
    v_mul_f32 v56, v72, v56
    v_mfma_f32_16x16x32_bf16 v[160:163], a[68:71], a[4:7], v[160:163]
    v_mul_f32 v57, v72, v57
    v_mfma_f32_16x16x32_bf16 v[160:163], a[72:75], a[8:11], v[160:163]
    buffer_load_dwordx4 v20, s[8:11], s53 offen offset:3072 lds
    v_mul_f32 v58, v72, v58
    v_mfma_f32_16x16x32_bf16 v[160:163], a[76:79], a[12:15], v[160:163]
    v_mul_f32 v59, v72, v59
    v_mfma_f32_16x16x32_bf16 v[160:163], a[80:83], a[16:19], v[160:163]
    v_mul_f32 v60, v73, v60
    v_mfma_f32_16x16x32_bf16 v[160:163], a[84:87], a[20:23], v[160:163]
    v_mul_f32 v61, v73, v61
    v_mfma_f32_16x16x32_bf16 v[160:163], a[88:91], a[24:27], v[160:163]
    v_mul_f32 v62, v73, v62
    v_mfma_f32_16x16x32_bf16 v[160:163], a[92:95], a[28:31], v[160:163]
    s_add_u32 m0, s47, 0x20000
    s_add_u32 s53, s23, 0x0
    buffer_load_dwordx4 v21, s[4:7], s53 offen offset:0 lds
    v_mul_f32 v63, v73, v63
    v_mfma_f32_16x16x32_bf16 v[160:163], a[96:99], a[32:35], v[160:163]
    v_mul_f32 v64, v74, v64
    v_mfma_f32_16x16x32_bf16 v[160:163], a[100:103], a[36:39], v[160:163]
    v_mul_f32 v65, v74, v65
    v_mfma_f32_16x16x32_bf16 v[160:163], a[104:107], a[40:43], v[160:163]
    v_mul_f32 v66, v74, v66
    v_mfma_f32_16x16x32_bf16 v[160:163], a[108:111], a[44:47], v[160:163]
    v_mul_f32 v67, v74, v67
    v_mfma_f32_16x16x32_bf16 v[160:163], a[112:115], a[48:51], v[160:163]
    s_add_u32 s53, s23, 0x1c00
    buffer_load_dwordx4 v21, s[4:7], s53 offen offset:1024 lds
    v_mul_f32 v68, v75, v68
    v_mfma_f32_16x16x32_bf16 v[160:163], a[116:119], a[52:55], v[160:163]
    v_mul_f32 v69, v75, v69
    v_mfma_f32_16x16x32_bf16 v[160:163], a[120:123], a[56:59], v[160:163]
    v_mul_f32 v70, v75, v70
    v_mfma_f32_16x16x32_bf16 v[160:163], a[124:127], a[60:63], v[160:163]
    v_mul_f32 v71, v75, v71
    s_mov_b32 s44, 0
    s_waitcnt vmcnt(7)
LY_chk_E_1:
    v_perm_b32 v240, v43, v42, s35
    v_perm_b32 v241, v47, v46, s35
    v_perm_b32 v242, v49, v48, s35
    v_perm_b32 v243, v51, v50, s35
    v_xor_b32 v240, v240, v192
    v_xor_b32 v241, v241, v193
    v_xor_b32 v242, v242, v194
    v_xor_b32 v243, v243, v195
    v_or3_b32 v240, v240, v241, v242
    v_or_b32 v240, v240, v243
    v_cmp_ne_u32 vcc, 0, v240
    s_nop 0
    s_cbranch_vccz LY_ok_E_2
    buffer_load_dwordx2 v[42:43], v95, s[80:83], 0 offen sc1
    buffer_load_dwordx2 v[46:47], v186, s[80:83], 0 offen sc1
    buffer_load_dwordx2 v[48:49], v187, s[80:83], 0 offen sc1
    buffer_load_dwordx2 v[50:51], v188, s[80:83], 0 offen sc1
    s_add_u32 s44, s44, 1
    s_cmp_lt_u32 s44, 0x10000
    s_waitcnt vmcnt(0)
    s_cbranch_scc1 LY_chk_E_1
LY_ok_E_2:
    v_and_b32 v50, s19, v50
    v_and_b32 v51, s19, v51
    v_and_b32 v48, s19, v48
    v_and_b32 v49, s19, v49
    v_and_b32 v46, s19, v46
    v_and_b32 v47, s19, v47
    v_and_b32 v42, s19, v42
    v_and_b32 v43, s19, v43
    v_pk_fma_f32 v[48:49], v[170:171], v[50:51], v[48:49] op_sel_hi:[0,1,1]
    v_pk_fma_f32 v[48:49], v[170:171], v[50:51], v[48:49] op_sel:[1,1,0] op_sel_hi:[1,0,1] neg_lo:[1,0,0]
    v_pk_fma_f32 v[46:47], v[170:171], v[48:49], v[46:47] op_sel_hi:[0,1,1]
    v_pk_fma_f32 v[46:47], v[170:171], v[48:49], v[46:47] op_sel:[1,1,0] op_sel_hi:[1,0,1] neg_lo:[1,0,0]
    v_pk_fma_f32 v[42:43], v[170:171], v[46:47], v[42:43] op_sel_hi:[0,1,1]
    v_pk_fma_f32 v[42:43], v[170:171], v[46:47], v[42:43] op_sel:[1,1,0] op_sel_hi:[1,0,1] neg_lo:[1,0,0]
    v_pk_mul_f32 v[8:9], v[172:173], v[42:43] op_sel_hi:[0,1]
    v_pk_fma_f32 v[8:9], v[172:173], v[42:43], v[8:9] op_sel:[1,1,0] op_sel_hi:[1,0,1] neg_lo:[1,0,0]
    v_mov_b32 v12, v8
    v_mov_b32 v13, v9
    s_nop 0
    v_permlane16_swap_b32 v8, v12
    v_permlane16_swap_b32 v9, v13
    v_pk_add_f32 v[8:9], v[8:9], v[12:13]
    v_mov_b32 v12, v8
    v_mov_b32 v13, v9
    s_nop 0
    v_permlane32_swap_b32 v8, v12
    v_permlane32_swap_b32 v9, v13
    v_pk_add_f32 v[8:9], v[8:9], v[12:13]
    v_pk_fma_f32 v[198:199], v[8:9], v[176:177], v[34:35] op_sel_hi:[0,1,1]
    v_pk_fma_f32 v[200:201], v[8:9], v[178:179], v[36:37] op_sel_hi:[0,1,1] neg_lo:[1,0,1] neg_hi:[1,0,1]
    v_pk_fma_f32 v[198:199], v[8:9], v[178:179], v[198:199] op_sel:[1,0,0] neg_lo:[1,0,0] neg_hi:[1,0,0]
    v_pk_fma_f32 v[200:201], v[8:9], v[176:177], v[200:201] op_sel:[1,0,0] neg_lo:[1,0,0] neg_hi:[1,0,0]
    v_pk_fma_f32 v[208:209], v[164:165], v[198:199], v[208:209] op_sel_hi:[0,1,1]
    v_pk_fma_f32 v[128:129], v[164:165], v[200:201], v[128:129] op_sel_hi:[0,1,1]
    v_pk_fma_f32 v[208:209], v[164:165], v[200:201], v[208:209] op_sel:[1,0,0]
    v_pk_fma_f32 v[128:129], v[164:165], v[198:199], v[128:129] op_sel:[1,0,0] neg_lo:[1,0,0] neg_hi:[1,0,0]
    v_pk_fma_f32 v[210:211], v[164:165], v[208:209], v[210:211] op_sel_hi:[0,1,1]
    v_pk_fma_f32 v[130:131], v[164:165], v[128:129], v[130:131] op_sel_hi:[0,1,1]
    v_pk_fma_f32 v[210:211], v[164:165], v[128:129], v[210:211] op_sel:[1,0,0]
    v_pk_fma_f32 v[130:131], v[164:165], v[208:209], v[130:131] op_sel:[1,0,0] neg_lo:[1,0,0] neg_hi:[1,0,0]
    v_cvt_pk_bf16_f32 v48, v208, v209
    v_cvt_pk_bf16_f32 v49, v210, v211
    v_cvt_pk_bf16_f32 v50, v128, v129
    v_cvt_pk_bf16_f32 v51, v130, v131
    ds_write_b128 v191, v[48:51] offset:0
    ds_read_b64_tr_b16 v[100:101], v196 offset:0
    ds_read_b64_tr_b16 v[102:103], v196 offset:64
    v_pk_fma_f32 v[212:213], v[164:165], v[210:211], v[212:213] op_sel_hi:[0,1,1]
    v_pk_fma_f32 v[132:133], v[164:165], v[130:131], v[132:133] op_sel_hi:[0,1,1]
    v_pk_fma_f32 v[212:213], v[164:165], v[130:131], v[212:213] op_sel:[1,0,0]
    v_pk_fma_f32 v[132:133], v[164:165], v[210:211], v[132:133] op_sel:[1,0,0] neg_lo:[1,0,0] neg_hi:[1,0,0]
    v_pk_fma_f32 v[214:215], v[164:165], v[212:213], v[214:215] op_sel_hi:[0,1,1]
    v_pk_fma_f32 v[134:135], v[164:165], v[132:133], v[134:135] op_sel_hi:[0,1,1]
    v_pk_fma_f32 v[214:215], v[164:165], v[132:133], v[214:215] op_sel:[1,0,0]
    v_pk_fma_f32 v[134:135], v[164:165], v[212:213], v[134:135] op_sel:[1,0,0] neg_lo:[1,0,0] neg_hi:[1,0,0]
    v_cvt_pk_bf16_f32 v96, v212, v213
    v_cvt_pk_bf16_f32 v97, v214, v215
    v_cvt_pk_bf16_f32 v98, v132, v133
    v_cvt_pk_bf16_f32 v99, v134, v135
    ds_write_b128 v191, v[96:99] offset:1280
    ds_read_b64_tr_b16 v[104:105], v196 offset:1280
    ds_read_b64_tr_b16 v[106:107], v196 offset:1344
    v_pk_fma_f32 v[216:217], v[164:165], v[214:215], v[216:217] op_sel_hi:[0,1,1]
    v_pk_fma_f32 v[136:137], v[164:165], v[134:135], v[136:137] op_sel_hi:[0,1,1]
    v_pk_fma_f32 v[216:217], v[164:165], v[134:135], v[216:217] op_sel:[1,0,0]
    v_pk_fma_f32 v[136:137], v[164:165], v[214:215], v[136:137] op_sel:[1,0,0] neg_lo:[1,0,0] neg_hi:[1,0,0]
    v_pk_fma_f32 v[218:219], v[164:165], v[216:217], v[218:219] op_sel_hi:[0,1,1]
    v_pk_fma_f32 v[138:139], v[164:165], v[136:137], v[138:139] op_sel_hi:[0,1,1]
    v_pk_fma_f32 v[218:219], v[164:165], v[136:137], v[218:219] op_sel:[1,0,0]
    v_pk_fma_f32 v[138:139], v[164:165], v[216:217], v[138:139] op_sel:[1,0,0] neg_lo:[1,0,0] neg_hi:[1,0,0]
    v_cvt_pk_bf16_f32 v48, v216, v217
    v_cvt_pk_bf16_f32 v49, v218, v219
    v_cvt_pk_bf16_f32 v50, v136, v137
    v_cvt_pk_bf16_f32 v51, v138, v139
    s_waitcnt lgkmcnt(3)
    buffer_store_dwordx4 v[100:103], v88, s[80:83], s50 offen sc1
    ds_write_b128 v191, v[48:51] offset:2560
    ds_read_b64_tr_b16 v[108:109], v196 offset:2560
    ds_read_b64_tr_b16 v[110:111], v196 offset:2624
    v_pk_fma_f32 v[220:221], v[164:165], v[218:219], v[220:221] op_sel_hi:[0,1,1]
    v_pk_fma_f32 v[140:141], v[164:165], v[138:139], v[140:141] op_sel_hi:[0,1,1]
    v_pk_fma_f32 v[220:221], v[164:165], v[138:139], v[220:221] op_sel:[1,0,0]
    v_pk_fma_f32 v[140:141], v[164:165], v[218:219], v[140:141] op_sel:[1,0,0] neg_lo:[1,0,0] neg_hi:[1,0,0]
    v_pk_fma_f32 v[222:223], v[164:165], v[220:221], v[222:223] op_sel_hi:[0,1,1]
    v_pk_fma_f32 v[142:143], v[164:165], v[140:141], v[142:143] op_sel_hi:[0,1,1]
    v_pk_fma_f32 v[222:223], v[164:165], v[140:141], v[222:223] op_sel:[1,0,0]
    v_pk_fma_f32 v[142:143], v[164:165], v[220:221], v[142:143] op_sel:[1,0,0] neg_lo:[1,0,0] neg_hi:[1,0,0]
    v_cvt_pk_bf16_f32 v96, v220, v221
    v_cvt_pk_bf16_f32 v97, v222, v223
    v_cvt_pk_bf16_f32 v98, v140, v141
    v_cvt_pk_bf16_f32 v99, v142, v143
    s_add_u32 s50, s50, s77
    s_waitcnt lgkmcnt(3)
    buffer_store_dwordx4 v[104:107], v88, s[80:83], s50 offen sc1
    ds_write_b128 v191, v[96:99] offset:0
    ds_read_b64_tr_b16 v[100:101], v196 offset:0
    ds_read_b64_tr_b16 v[102:103], v196 offset:64
    v_pk_fma_f32 v[224:225], v[164:165], v[222:223], v[224:225] op_sel_hi:[0,1,1]
    v_pk_fma_f32 v[144:145], v[164:165], v[142:143], v[144:145] op_sel_hi:[0,1,1]
    v_pk_fma_f32 v[224:225], v[164:165], v[142:143], v[224:225] op_sel:[1,0,0]
    v_pk_fma_f32 v[144:145], v[164:165], v[222:223], v[144:145] op_sel:[1,0,0] neg_lo:[1,0,0] neg_hi:[1,0,0]
    v_pk_fma_f32 v[226:227], v[164:165], v[224:225], v[226:227] op_sel_hi:[0,1,1]
    v_pk_fma_f32 v[146:147], v[164:165], v[144:145], v[146:147] op_sel_hi:[0,1,1]
    v_pk_fma_f32 v[226:227], v[164:165], v[144:145], v[226:227] op_sel:[1,0,0]
    v_pk_fma_f32 v[146:147], v[164:165], v[224:225], v[146:147] op_sel:[1,0,0] neg_lo:[1,0,0] neg_hi:[1,0,0]
    v_cvt_pk_bf16_f32 v48, v224, v225
    v_cvt_pk_bf16_f32 v49, v226, v227
    v_cvt_pk_bf16_f32 v50, v144, v145
    v_cvt_pk_bf16_f32 v51, v146, v147
    s_add_u32 s50, s50, s77
    s_waitcnt lgkmcnt(3)
    buffer_store_dwordx4 v[108:111], v88, s[80:83], s50 offen sc1
    ds_write_b128 v191, v[48:51] offset:1280
    ds_read_b64_tr_b16 v[104:105], v196 offset:1280
    ds_read_b64_tr_b16 v[106:107], v196 offset:1344
    v_pk_fma_f32 v[228:229], v[164:165], v[226:227], v[228:229] op_sel_hi:[0,1,1]
    v_pk_fma_f32 v[148:149], v[164:165], v[146:147], v[148:149] op_sel_hi:[0,1,1]
    v_pk_fma_f32 v[228:229], v[164:165], v[146:147], v[228:229] op_sel:[1,0,0]
    v_pk_fma_f32 v[148:149], v[164:165], v[226:227], v[148:149] op_sel:[1,0,0] neg_lo:[1,0,0] neg_hi:[1,0,0]
    v_pk_fma_f32 v[230:231], v[164:165], v[228:229], v[230:231] op_sel_hi:[0,1,1]
    v_pk_fma_f32 v[150:151], v[164:165], v[148:149], v[150:151] op_sel_hi:[0,1,1]
    v_pk_fma_f32 v[230:231], v[164:165], v[148:149], v[230:231] op_sel:[1,0,0]
    v_pk_fma_f32 v[150:151], v[164:165], v[228:229], v[150:151] op_sel:[1,0,0] neg_lo:[1,0,0] neg_hi:[1,0,0]
    v_cvt_pk_bf16_f32 v96, v228, v229
    v_cvt_pk_bf16_f32 v97, v230, v231
    v_cvt_pk_bf16_f32 v98, v148, v149
    v_cvt_pk_bf16_f32 v99, v150, v151
    s_add_u32 s50, s50, s77
    s_waitcnt lgkmcnt(3)
    buffer_store_dwordx4 v[100:103], v88, s[80:83], s50 offen sc1
    ds_write_b128 v191, v[96:99] offset:2560
    ds_read_b64_tr_b16 v[108:109], v196 offset:2560
    ds_read_b64_tr_b16 v[110:111], v196 offset:2624
    v_pk_fma_f32 v[232:233], v[164:165], v[230:231], v[232:233] op_sel_hi:[0,1,1]
    v_pk_fma_f32 v[152:153], v[164:165], v[150:151], v[152:153] op_sel_hi:[0,1,1]
    v_pk_fma_f32 v[232:233], v[164:165], v[150:151], v[232:233] op_sel:[1,0,0]
    v_pk_fma_f32 v[152:153], v[164:165], v[230:231], v[152:153] op_sel:[1,0,0] neg_lo:[1,0,0] neg_hi:[1,0,0]
    v_pk_fma_f32 v[234:235], v[164:165], v[232:233], v[234:235] op_sel_hi:[0,1,1]
    v_pk_fma_f32 v[154:155], v[164:165], v[152:153], v[154:155] op_sel_hi:[0,1,1]
    v_pk_fma_f32 v[234:235], v[164:165], v[152:153], v[234:235] op_sel:[1,0,0]
    v_pk_fma_f32 v[154:155], v[164:165], v[232:233], v[154:155] op_sel:[1,0,0] neg_lo:[1,0,0] neg_hi:[1,0,0]
    v_cvt_pk_bf16_f32 v48, v232, v233
    v_cvt_pk_bf16_f32 v49, v234, v235
    v_cvt_pk_bf16_f32 v50, v152, v153
    v_cvt_pk_bf16_f32 v51, v154, v155
    s_add_u32 s50, s50, s77
    s_waitcnt lgkmcnt(3)
    buffer_store_dwordx4 v[104:107], v88, s[80:83], s50 offen sc1
    ds_write_b128 v191, v[48:51] offset:0
    ds_read_b64_tr_b16 v[100:101], v196 offset:0
    ds_read_b64_tr_b16 v[102:103], v196 offset:64
    v_pk_fma_f32 v[236:237], v[164:165], v[234:235], v[236:237] op_sel_hi:[0,1,1]
    v_pk_fma_f32 v[156:157], v[164:165], v[154:155], v[156:157] op_sel_hi:[0,1,1]
    v_pk_fma_f32 v[236:237], v[164:165], v[154:155], v[236:237] op_sel:[1,0,0]
    v_pk_fma_f32 v[156:157], v[164:165], v[234:235], v[156:157] op_sel:[1,0,0] neg_lo:[1,0,0] neg_hi:[1,0,0]
    v_pk_fma_f32 v[238:239], v[164:165], v[236:237], v[238:239] op_sel_hi:[0,1,1]
    v_pk_fma_f32 v[158:159], v[164:165], v[156:157], v[158:159] op_sel_hi:[0,1,1]
    v_pk_fma_f32 v[238:239], v[164:165], v[156:157], v[238:239] op_sel:[1,0,0]
    v_pk_fma_f32 v[158:159], v[164:165], v[236:237], v[158:159] op_sel:[1,0,0] neg_lo:[1,0,0] neg_hi:[1,0,0]
    v_cvt_pk_bf16_f32 v96, v236, v237
    v_cvt_pk_bf16_f32 v97, v238, v239
    v_cvt_pk_bf16_f32 v98, v156, v157
    v_cvt_pk_bf16_f32 v99, v158, v159
    s_add_u32 s50, s50, s77
    s_waitcnt lgkmcnt(3)
    buffer_store_dwordx4 v[108:111], v88, s[80:83], s50 offen sc1
    ds_write_b128 v191, v[96:99] offset:1280
    ds_read_b64_tr_b16 v[104:105], v196 offset:1280
    ds_read_b64_tr_b16 v[106:107], v196 offset:1344
    s_add_u32 s50, s50, s77
    s_waitcnt lgkmcnt(3)
    buffer_store_dwordx4 v[100:103], v88, s[80:83], s50 offen sc1
    s_add_u32 s50, s50, s77
    s_waitcnt lgkmcnt(0)
    buffer_store_dwordx4 v[104:107], v88, s[80:83], s50 offen sc1
    s_add_u32 s53, s23, 0x3800
    buffer_load_dwordx4 v21, s[4:7], s53 offen offset:2048 lds
    ds_read_b128 a[64:67], v53 offset:0
    ds_read_b128 a[68:71], v53 offset:4096
    ds_read_b128 a[72:75], v53 offset:8192
    ds_read_b128 a[76:79], v53 offset:12288
    v_mul_f32 v160, 0xbfb8aa3b, v160
    v_mul_f32 v161, 0xbfb8aa3b, v161
    s_add_u32 s53, s23, 0x5400
    buffer_load_dwordx4 v21, s[4:7], s53 offen offset:3072 lds
    ds_read_b128 a[80:83], v54 offset:0
    ds_read_b128 a[84:87], v54 offset:4096
    ds_read_b128 a[88:91], v54 offset:8192
    ds_read_b128 a[92:95], v54 offset:12288
    v_mul_f32 v162, 0xbfb8aa3b, v162
    v_mul_f32 v163, 0xbfb8aa3b, v163
    s_add_u32 m0, s47, 0x24000
    s_add_u32 s53, s23, 0x20000
    buffer_load_dwordx4 v21, s[4:7], s53 offen offset:0 lds
    ds_read_b128 a[96:99], v55 offset:0
    ds_read_b128 a[100:103], v55 offset:4096
    ds_read_b128 a[104:107], v55 offset:8192
    ds_read_b128 a[108:111], v55 offset:12288
    v_exp_f32 v160, v160
    v_exp_f32 v161, v161
    s_add_u32 s53, s23, 0x21c00
    buffer_load_dwordx4 v21, s[4:7], s53 offen offset:1024 lds
    ds_read_b128 a[112:115], v76 offset:0
    ds_read_b128 a[116:119], v76 offset:4096
    ds_read_b128 a[120:123], v76 offset:8192
    ds_read_b128 a[124:127], v76 offset:12288
    v_exp_f32 v162, v162
    v_exp_f32 v163, v163
    s_add_u32 s53, s23, 0x23800
    buffer_load_dwordx4 v21, s[4:7], s53 offen offset:2048 lds
    ds_read_b128 a[128:131], v53 offset:16384
    ds_read_b128 a[132:135], v53 offset:20480
    ds_read_b128 a[136:139], v53 offset:24576
    ds_read_b128 a[140:143], v53 offset:28672
    v_add_f32 v160, 1.0, v160
    v_add_f32 v161, 1.0, v161
    s_add_u32 s53, s23, 0x25400
    buffer_load_dwordx4 v21, s[4:7], s53 offen offset:3072 lds
    ds_read_b128 a[144:147], v54 offset:16384
    ds_read_b128 a[148:151], v54 offset:20480
    ds_read_b128 a[152:155], v54 offset:24576
    ds_read_b128 a[156:159], v54 offset:28672
    v_add_f32 v162, 1.0, v162
    v_add_f32 v163, 1.0, v163
    ds_read_b128 a[160:163], v55 offset:16384
    ds_read_b128 a[164:167], v55 offset:20480
    ds_read_b128 a[168:171], v55 offset:24576
    ds_read_b128 a[172:175], v55 offset:28672
    v_rcp_f32 v160, v160
    v_rcp_f32 v161, v161
    ds_read_b128 a[176:179], v76 offset:16384
    ds_read_b128 a[180:183], v76 offset:20480
    ds_read_b128 a[184:187], v76 offset:24576
    ds_read_b128 a[188:191], v76 offset:28672
    v_rcp_f32 v162, v162
    v_rcp_f32 v163, v163
    s_waitcnt vmcnt(6)
    s_waitcnt lgkmcnt(0)
    s_barrier
    s_cmp_lg_u32 s3, 0
    s_cbranch_scc1 LY_nosend_3
    s_mov_b64 exec, 0xffff
    buffer_atomic_swap v91, v89, s[80:83], s16 offen offset:128 sc1
    s_mov_b64 exec, -1
LY_nosend_3:
    ds_read_b128 a[192:195], v53 offset:32768
    ds_read_b128 a[196:199], v53 offset:36864
    ds_read_b128 a[200:203], v53 offset:40960
    ds_read_b128 a[204:207], v53 offset:45056
    ds_read_b128 a[208:211], v54 offset:32768
    ds_read_b128 a[212:215], v54 offset:36864
    ds_read_b128 a[216:219], v54 offset:40960
    ds_read_b128 a[220:223], v54 offset:45056
    v_mov_b32 v86, 0
    s_mov_b64 exec, 0xff
    buffer_atomic_add v86, v85, s[80:83], s15 offen offset:128 sc0 sc1
    s_mov_b64 exec, -1
    s_add_u32 m0, s47, 0x0
    s_add_u32 s53, s23, 0x40000
    buffer_load_dwordx4 v21, s[4:7], s53 offen offset:0 lds
    ds_read_b128 a[224:227], v55 offset:32768
    ds_read_b128 a[228:231], v55 offset:36864
    ds_read_b128 a[232:235], v55 offset:40960
    ds_read_b128 a[236:239], v55 offset:45056
    s_add_u32 s53, s23, 0x41c00
    buffer_load_dwordx4 v21, s[4:7], s53 offen offset:1024 lds
    ds_read_b128 a[240:243], v76 offset:32768
    ds_read_b128 a[244:247], v76 offset:36864
    ds_read_b128 a[248:251], v76 offset:40960
    ds_read_b128 a[252:255], v76 offset:45056
    s_add_u32 s53, s23, 0x43800
    buffer_load_dwordx4 v21, s[4:7], s53 offen offset:2048 lds
    s_add_u32 s53, s23, 0x45400
    buffer_load_dwordx4 v21, s[4:7], s53 offen offset:3072 lds
    s_add_u32 m0, s47, 0x4000
    s_add_u32 s53, s23, 0x60000
    buffer_load_dwordx4 v21, s[4:7], s53 offen offset:0 lds
    s_add_u32 s53, s23, 0x61c00
    buffer_load_dwordx4 v21, s[4:7], s53 offen offset:1024 lds
    s_add_u32 s53, s23, 0x63800
    buffer_load_dwordx4 v21, s[4:7], s53 offen offset:2048 lds
    s_add_u32 s53, s23, 0x65400
    buffer_load_dwordx4 v21, s[4:7], s53 offen offset:3072 lds
    v_mov_b32 v94, 0
    s_mov_b64 exec, 0xff
    buffer_atomic_add v94, v85, s[80:83], s15 offen offset:128 sc0 sc1
    s_mov_b64 exec, -1
    s_branch LY_pg1
.p2align 12
LY_pg1:
    s_mov_b32 s44, 0
    s_waitcnt vmcnt(9)
LY_chk_fh_4:
    v_cmp_ne_u32 vcc, s43, v86
    s_nop 0
    s_and_b64 vcc, vcc, 0xff
    s_cbranch_vccz LY_ok_fh_5
    v_mov_b32 v86, 0
    s_mov_b64 exec, 0xff
    buffer_atomic_add v86, v85, s[80:83], s15 offen offset:128 sc0 sc1
    s_mov_b64 exec, -1
    s_waitcnt vmcnt(1)
    v_cmp_ne_u32 vcc, s43, v94
    s_nop 0
    s_and_b64 vcc, vcc, 0xff
    s_cbranch_vccz LY_ok_fh_5
    v_mov_b32 v94, 0
    s_mov_b64 exec, 0xff
    buffer_atomic_add v94, v85, s[80:83], s15 offen offset:128 sc0 sc1
    s_mov_b64 exec, -1
    s_add_u32 s44, s44, 1
    s_cmp_lt_u32 s44, 0x10000
    s_waitcnt vmcnt(1)
    s_cbranch_scc1 LY_chk_fh_4
LY_ok_fh_5:
    buffer_load_dwordx4 a[0:3], v88, s[80:83], s14 offen offset:0 sc1
    buffer_load_dwordx4 a[4:7], v88, s[80:83], s14 offen offset:128 sc1
    buffer_load_dwordx4 a[8:11], v88, s[80:83], s14 offen offset:256 sc1
    buffer_load_dwordx4 a[12:15], v88, s[80:83], s14 offen offset:512 sc1
    buffer_load_dwordx4 a[16:19], v88, s[80:83], s14 offen offset:640 sc1
    buffer_load_dwordx4 a[20:23], v88, s[80:83], s14 offen offset:768 sc1
    s_addk_i32 s14, 0x2000
    buffer_load_dwordx4 a[24:27], v88, s[80:83], s14 offen offset:0 sc1
    buffer_load_dwordx4 a[28:31], v88, s[80:83], s14 offen offset:128 sc1
    s_waitcnt vmcnt(7)
    v_mfma_f32_16x16x32_bf16 v[56:59], a[0:3], a[64:67], v[56:59]
    s_waitcnt vmcnt(6)
    buffer_load_dwordx4 a[32:35], v88, s[80:83], s14 offen offset:256 sc1
    v_mfma_f32_16x16x32_bf16 v[60:63], a[0:3], a[68:71], v[60:63]
    v_mfma_f32_16x16x32_bf16 v[64:67], a[0:3], a[72:75], v[64:67]
    buffer_load_dwordx4 a[36:39], v88, s[80:83], s14 offen offset:512 sc1
    v_mfma_f32_16x16x32_bf16 v[68:71], a[0:3], a[76:79], v[68:71]
    v_mfma_f32_16x16x32_bf16 v[56:59], a[4:7], a[80:83], v[56:59]
    s_waitcnt vmcnt(7)
    ds_read_b128 a[64:67], v53 offset:49152
    buffer_load_dwordx4 a[40:43], v88, s[80:83], s14 offen offset:640 sc1
    v_mfma_f32_16x16x32_bf16 v[60:63], a[4:7], a[84:87], v[60:63]
    ds_read_b128 a[68:71], v53 offset:53248
    ds_read_b128 a[72:75], v53 offset:57344
    v_mfma_f32_16x16x32_bf16 v[64:67], a[4:7], a[88:91], v[64:67]
    buffer_load_dwordx4 a[44:47], v88, s[80:83], s14 offen offset:768 sc1
    v_mfma_f32_16x16x32_bf16 v[68:71], a[4:7], a[92:95], v[68:71]
    ds_read_b128 a[76:79], v53 offset:61440
    s_barrier
    v_mfma_f32_16x16x32_bf16 v[56:59], a[8:11], a[96:99], v[56:59]
    s_waitcnt vmcnt(8)
    ds_read_b128 a[80:83], v54 offset:49152
    s_addk_i32 s14, 0x2000
    buffer_load_dwordx4 a[48:51], v88, s[80:83], s14 offen offset:0 sc1
    v_mfma_f32_16x16x32_bf16 v[60:63], a[8:11], a[100:103], v[60:63]
    ds_read_b128 a[84:87], v54 offset:53248
    ds_read_b128 a[88:91], v54 offset:57344
    v_mfma_f32_16x16x32_bf16 v[64:67], a[8:11], a[104:107], v[64:67]
    buffer_load_dwordx4 a[52:55], v88, s[80:83], s14 offen offset:128 sc1
    v_mfma_f32_16x16x32_bf16 v[68:71], a[8:11], a[108:111], v[68:71]
    ds_read_b128 a[92:95], v54 offset:61440
    v_mfma_f32_16x16x32_bf16 v[56:59], a[12:15], a[112:115], v[56:59]
    s_waitcnt vmcnt(9)
    ds_read_b128 a[96:99], v55 offset:49152
    v_mfma_f32_16x16x32_bf16 v[60:63], a[12:15], a[116:119], v[60:63]
    ds_read_b128 a[100:103], v55 offset:53248
    ds_read_b128 a[104:107], v55 offset:57344
    v_mfma_f32_16x16x32_bf16 v[64:67], a[12:15], a[120:123], v[64:67]
    buffer_load_dwordx4 a[56:59], v88, s[80:83], s14 offen offset:256 sc1
    v_mfma_f32_16x16x32_bf16 v[68:71], a[12:15], a[124:127], v[68:71]
    ds_read_b128 a[108:111], v55 offset:61440
    v_mfma_f32_16x16x32_bf16 v[56:59], a[16:19], a[128:131], v[56:59]
    s_waitcnt vmcnt(9)
    ds_read_b128 a[112:115], v76 offset:49152
    v_mfma_f32_16x16x32_bf16 v[60:63], a[16:19], a[132:135], v[60:63]
    ds_read_b128 a[116:119], v76 offset:53248
    ds_read_b128 a[120:123], v76 offset:57344
    v_mfma_f32_16x16x32_bf16 v[64:67], a[16:19], a[136:139], v[64:67]
    buffer_load_dwordx4 a[60:63], v88, s[80:83], s14 offen offset:512 sc1
    v_mfma_f32_16x16x32_bf16 v[68:71], a[16:19], a[140:143], v[68:71]
    ds_read_b128 a[124:127], v76 offset:61440
    v_mfma_f32_16x16x32_bf16 v[56:59], a[20:23], a[144:147], v[56:59]
    s_waitcnt vmcnt(9)
    ds_read_b128 a[128:131], v77 offset:0
    v_mfma_f32_16x16x32_bf16 v[60:63], a[20:23], a[148:151], v[60:63]
    ds_read_b128 a[132:135], v77 offset:4096
    ds_read_b128 a[136:139], v77 offset:8192
    v_mfma_f32_16x16x32_bf16 v[64:67], a[20:23], a[152:155], v[64:67]
    buffer_load_dwordx4 a[0:3], v88, s[80:83], s14 offen offset:640 sc1
    v_mfma_f32_16x16x32_bf16 v[68:71], a[20:23], a[156:159], v[68:71]
    ds_read_b128 a[140:143], v77 offset:12288
    v_mfma_f32_16x16x32_bf16 v[56:59], a[24:27], a[160:163], v[56:59]
    s_waitcnt vmcnt(9)
    ds_read_b128 a[144:147], v78 offset:0
    v_mfma_f32_16x16x32_bf16 v[60:63], a[24:27], a[164:167], v[60:63]
    ds_read_b128 a[148:151], v78 offset:4096
    ds_read_b128 a[152:155], v78 offset:8192
    v_mfma_f32_16x16x32_bf16 v[64:67], a[24:27], a[168:171], v[64:67]
    buffer_load_dwordx4 a[4:7], v88, s[80:83], s14 offen offset:768 sc1
    v_mfma_f32_16x16x32_bf16 v[68:71], a[24:27], a[172:175], v[68:71]
    ds_read_b128 a[156:159], v78 offset:12288
    v_mfma_f32_16x16x32_bf16 v[56:59], a[28:31], a[176:179], v[56:59]
    s_waitcnt vmcnt(9) lgkmcnt(15)
    ds_read_b128 a[160:163], v79 offset:0
    v_mfma_f32_16x16x32_bf16 v[60:63], a[28:31], a[180:183], v[60:63]
    ds_read_b128 a[164:167], v79 offset:4096
    ds_read_b128 a[168:171], v79 offset:8192
    v_mfma_f32_16x16x32_bf16 v[64:67], a[28:31], a[184:187], v[64:67]
    s_addk_i32 s14, 0x2000
    buffer_load_dwordx4 a[8:11], v88, s[80:83], s14 offen offset:0 sc1
    v_mfma_f32_16x16x32_bf16 v[68:71], a[28:31], a[188:191], v[68:71]
    ds_read_b128 a[172:175], v79 offset:12288
    v_mfma_f32_16x16x32_bf16 v[56:59], a[32:35], a[192:195], v[56:59]
    s_waitcnt vmcnt(9)
    ds_read_b128 a[176:179], v80 offset:0
    v_mfma_f32_16x16x32_bf16 v[60:63], a[32:35], a[196:199], v[60:63]
    ds_read_b128 a[180:183], v80 offset:4096
    ds_read_b128 a[184:187], v80 offset:8192
    v_mfma_f32_16x16x32_bf16 v[64:67], a[32:35], a[200:203], v[64:67]
    buffer_load_dwordx4 a[12:15], v88, s[80:83], s14 offen offset:128 sc1
    v_mfma_f32_16x16x32_bf16 v[68:71], a[32:35], a[204:207], v[68:71]
    ds_read_b128 a[188:191], v80 offset:12288
    v_mfma_f32_16x16x32_bf16 v[56:59], a[36:39], a[208:211], v[56:59]
    s_waitcnt vmcnt(9)
    ds_read_b128 a[192:195], v77 offset:16384
    v_mfma_f32_16x16x32_bf16 v[60:63], a[36:39], a[212:215], v[60:63]
    ds_read_b128 a[196:199], v77 offset:20480
    ds_read_b128 a[200:203], v77 offset:24576
    v_mfma_f32_16x16x32_bf16 v[64:67], a[36:39], a[216:219], v[64:67]
    buffer_load_dwordx4 a[16:19], v88, s[80:83], s14 offen offset:256 sc1
    v_mfma_f32_16x16x32_bf16 v[68:71], a[36:39], a[220:223], v[68:71]
    ds_read_b128 a[204:207], v77 offset:28672
    v_mfma_f32_16x16x32_bf16 v[56:59], a[40:43], a[224:227], v[56:59]
    s_waitcnt vmcnt(9)
    ds_read_b128 a[208:211], v78 offset:16384
    v_mfma_f32_16x16x32_bf16 v[60:63], a[40:43], a[228:231], v[60:63]
    ds_read_b128 a[212:215], v78 offset:20480
    ds_read_b128 a[216:219], v78 offset:24576
    v_mfma_f32_16x16x32_bf16 v[64:67], a[40:43], a[232:235], v[64:67]
    buffer_load_dwordx4 a[20:23], v88, s[80:83], s14 offen offset:512 sc1
    v_mfma_f32_16x16x32_bf16 v[68:71], a[40:43], a[236:239], v[68:71]
    ds_read_b128 a[220:223], v78 offset:28672
    v_mfma_f32_16x16x32_bf16 v[56:59], a[44:47], a[240:243], v[56:59]
    s_waitcnt vmcnt(9)
    ds_read_b128 a[224:227], v79 offset:16384
    v_mfma_f32_16x16x32_bf16 v[60:63], a[44:47], a[244:247], v[60:63]
    ds_read_b128 a[228:231], v79 offset:20480
    ds_read_b128 a[232:235], v79 offset:24576
    v_mfma_f32_16x16x32_bf16 v[64:67], a[44:47], a[248:251], v[64:67]
    v_mov_b32 v87, 0
    s_mov_b64 exec, 0xff
    buffer_atomic_add v87, v85, s[80:83], s18 offen offset:256 sc0 sc1
    s_mov_b64 exec, -1
    buffer_load_dwordx4 a[24:27], v88, s[80:83], s14 offen offset:640 sc1
    v_mfma_f32_16x16x32_bf16 v[68:71], a[44:47], a[252:255], v[68:71]
    ds_read_b128 a[236:239], v79 offset:28672
    v_mfma_f32_16x16x32_bf16 v[56:59], a[48:51], a[64:67], v[56:59]
    s_waitcnt vmcnt(10)
    ds_read_b128 a[240:243], v80 offset:16384
    v_mfma_f32_16x16x32_bf16 v[60:63], a[48:51], a[68:71], v[60:63]
    ds_read_b128 a[244:247], v80 offset:20480
    ds_read_b128 a[248:251], v80 offset:24576
    v_mfma_f32_16x16x32_bf16 v[64:67], a[48:51], a[72:75], v[64:67]
    buffer_load_dwordx4 a[28:31], v88, s[80:83], s14 offen offset:768 sc1
    v_mfma_f32_16x16x32_bf16 v[68:71], a[48:51], a[76:79], v[68:71]
    ds_read_b128 a[252:255], v80 offset:28672
    v_mfma_f32_16x16x32_bf16 v[56:59], a[52:55], a[80:83], v[56:59]
    s_waitcnt vmcnt(10) lgkmcnt(15)
    ds_read_b128 a[64:67], v77 offset:32768
    v_mfma_f32_16x16x32_bf16 v[60:63], a[52:55], a[84:87], v[60:63]
    ds_read_b128 a[68:71], v77 offset:36864
    ds_read_b128 a[72:75], v77 offset:40960
    v_mfma_f32_16x16x32_bf16 v[64:67], a[52:55], a[88:91], v[64:67]
    s_addk_i32 s14, 0x2000
    buffer_load_dwordx4 a[32:35], v88, s[80:83], s14 offen offset:0 sc1
    v_mfma_f32_16x16x32_bf16 v[68:71], a[52:55], a[92:95], v[68:71]
    ds_read_b128 a[76:79], v77 offset:45056
    v_mfma_f32_16x16x32_bf16 v[56:59], a[56:59], a[96:99], v[56:59]
    s_waitcnt vmcnt(10)
    ds_read_b128 a[80:83], v78 offset:32768
    v_mfma_f32_16x16x32_bf16 v[60:63], a[56:59], a[100:103], v[60:63]
    ds_read_b128 a[84:87], v78 offset:36864
    ds_read_b128 a[88:91], v78 offset:40960
    v_mfma_f32_16x16x32_bf16 v[64:67], a[56:59], a[104:107], v[64:67]
    buffer_load_dwordx4 a[36:39], v88, s[80:83], s14 offen offset:128 sc1
    v_mfma_f32_16x16x32_bf16 v[68:71], a[56:59], a[108:111], v[68:71]
    ds_read_b128 a[92:95], v78 offset:45056
    v_mfma_f32_16x16x32_bf16 v[56:59], a[60:63], a[112:115], v[56:59]
    s_waitcnt vmcnt(10)
    ds_read_b128 a[96:99], v79 offset:32768
    v_mfma_f32_16x16x32_bf16 v[60:63], a[60:63], a[116:119], v[60:63]
    ds_read_b128 a[100:103], v79 offset:36864
    ds_read_b128 a[104:107], v79 offset:40960
    v_mfma_f32_16x16x32_bf16 v[64:67], a[60:63], a[120:123], v[64:67]
    buffer_load_dwordx4 a[40:43], v88, s[80:83], s14 offen offset:256 sc1
    v_mfma_f32_16x16x32_bf16 v[68:71], a[60:63], a[124:127], v[68:71]
    ds_read_b128 a[108:111], v79 offset:45056
    v_mfma_f32_16x16x32_bf16 v[56:59], a[0:3], a[128:131], v[56:59]
    s_waitcnt vmcnt(10)
    ds_read_b128 a[112:115], v80 offset:32768
    v_mfma_f32_16x16x32_bf16 v[60:63], a[0:3], a[132:135], v[60:63]
    ds_read_b128 a[116:119], v80 offset:36864
    ds_read_b128 a[120:123], v80 offset:40960
    v_mfma_f32_16x16x32_bf16 v[64:67], a[0:3], a[136:139], v[64:67]
    buffer_load_dwordx4 a[44:47], v88, s[80:83], s14 offen offset:512 sc1
    v_mfma_f32_16x16x32_bf16 v[68:71], a[0:3], a[140:143], v[68:71]
    ds_read_b128 a[124:127], v80 offset:45056
    v_mfma_f32_16x16x32_bf16 v[56:59], a[4:7], a[144:147], v[56:59]
    s_waitcnt vmcnt(10)
    ds_read_b128 a[128:131], v77 offset:49152
    v_mfma_f32_16x16x32_bf16 v[60:63], a[4:7], a[148:151], v[60:63]
    ds_read_b128 a[132:135], v77 offset:53248
    ds_read_b128 a[136:139], v77 offset:57344
    v_mfma_f32_16x16x32_bf16 v[64:67], a[4:7], a[152:155], v[64:67]
    buffer_load_dwordx4 a[48:51], v88, s[80:83], s14 offen offset:640 sc1
    v_mfma_f32_16x16x32_bf16 v[68:71], a[4:7], a[156:159], v[68:71]
    ds_read_b128 a[140:143], v77 offset:61440
    v_mfma_f32_16x16x32_bf16 v[56:59], a[8:11], a[160:163], v[56:59]
    s_waitcnt vmcnt(10)
    ds_read_b128 a[144:147], v78 offset:49152
    v_mfma_f32_16x16x32_bf16 v[60:63], a[8:11], a[164:167], v[60:63]
    ds_read_b128 a[148:151], v78 offset:53248
    ds_read_b128 a[152:155], v78 offset:57344
    v_mfma_f32_16x16x32_bf16 v[64:67], a[8:11], a[168:171], v[64:67]
    buffer_load_dwordx4 a[52:55], v88, s[80:83], s14 offen offset:768 sc1
    v_mfma_f32_16x16x32_bf16 v[68:71], a[8:11], a[172:175], v[68:71]
    ds_read_b128 a[156:159], v78 offset:61440
    v_mfma_f32_16x16x32_bf16 v[56:59], a[12:15], a[176:179], v[56:59]
    s_waitcnt vmcnt(10) lgkmcnt(15)
    ds_read_b128 a[160:163], v79 offset:49152
    v_mfma_f32_16x16x32_bf16 v[60:63], a[12:15], a[180:183], v[60:63]
    ds_read_b128 a[164:167], v79 offset:53248
    ds_read_b128 a[168:171], v79 offset:57344
    v_mfma_f32_16x16x32_bf16 v[64:67], a[12:15], a[184:187], v[64:67]
    s_addk_i32 s14, 0x2000
    buffer_load_dwordx4 a[56:59], v88, s[80:83], s14 offen offset:0 sc1
    v_mfma_f32_16x16x32_bf16 v[68:71], a[12:15], a[188:191], v[68:71]
    ds_read_b128 a[172:175], v79 offset:61440
    v_mfma_f32_16x16x32_bf16 v[56:59], a[16:19], a[192:195], v[56:59]
    s_waitcnt vmcnt(10)
    ds_read_b128 a[176:179], v80 offset:49152
    v_mfma_f32_16x16x32_bf16 v[60:63], a[16:19], a[196:199], v[60:63]
    ds_read_b128 a[180:183], v80 offset:53248
    ds_read_b128 a[184:187], v80 offset:57344
    v_mfma_f32_16x16x32_bf16 v[64:67], a[16:19], a[200:203], v[64:67]
    buffer_load_dwordx4 a[60:63], v88, s[80:83], s14 offen offset:128 sc1
    v_mfma_f32_16x16x32_bf16 v[68:71], a[16:19], a[204:207], v[68:71]
    ds_read_b128 a[188:191], v80 offset:61440
    v_mfma_f32_16x16x32_bf16 v[56:59], a[20:23], a[208:211], v[56:59]
    s_waitcnt vmcnt(9)
    ds_read_b64_tr_b16 a[192:193], v81 offset:0
    ds_read_b64_tr_b16 a[194:195], v81 offset:2048
    v_mfma_f32_16x16x32_bf16 v[60:63], a[20:23], a[212:215], v[60:63]
    ds_read_b64_tr_b16 a[196:197], v82 offset:0
    ds_read_b64_tr_b16 a[198:199], v82 offset:2048
    v_mfma_f32_16x16x32_bf16 v[64:67], a[20:23], a[216:219], v[64:67]
    s_mov_b32 s44, 0
LY_chk_fo_6:
    v_cmp_ne_u32 vcc, s43, v87
    s_nop 0
    s_and_b64 vcc, vcc, 0xff
    s_cbranch_vccz LY_ok_fo_7
    v_mov_b32 v87, 0
    s_mov_b64 exec, 0xff
    buffer_atomic_add v87, v85, s[80:83], s18 offen offset:256 sc0 sc1
    s_mov_b64 exec, -1
    s_add_u32 s44, s44, 1
    s_cmp_lt_u32 s44, 0x10000
    s_waitcnt vmcnt(0)
    s_cbranch_scc1 LY_chk_fo_6
LY_ok_fo_7:
    buffer_load_dwordx4 a[0:3], v88, s[80:83], s14 offen offset:256 sc1
    v_mfma_f32_16x16x32_bf16 v[68:71], a[20:23], a[220:223], v[68:71]
    ds_read_b64_tr_b16 a[200:201], v83 offset:0
    ds_read_b64_tr_b16 a[202:203], v83 offset:2048
    s_branch LY_pg2
.p2align 12
LY_pg2:
    v_mfma_f32_16x16x32_bf16 v[56:59], a[24:27], a[224:227], v[56:59]
    s_waitcnt vmcnt(9)
    ds_read_b64_tr_b16 a[204:205], v84 offset:0
    ds_read_b64_tr_b16 a[206:207], v84 offset:2048
    v_mfma_f32_16x16x32_bf16 v[60:63], a[24:27], a[228:231], v[60:63]
    ds_read_b64_tr_b16 a[208:209], v81 offset:4096
    ds_read_b64_tr_b16 a[210:211], v81 offset:6144
    v_mfma_f32_16x16x32_bf16 v[64:67], a[24:27], a[232:235], v[64:67]
    buffer_load_dwordx4 a[4:7], v88, s[80:83], s14 offen offset:512 sc1
    v_mfma_f32_16x16x32_bf16 v[68:71], a[24:27], a[236:239], v[68:71]
    ds_read_b64_tr_b16 a[212:213], v82 offset:4096
    ds_read_b64_tr_b16 a[214:215], v82 offset:6144
    v_mfma_f32_16x16x32_bf16 v[56:59], a[28:31], a[240:243], v[56:59]
    s_waitcnt vmcnt(9)
    ds_read_b64_tr_b16 a[216:217], v83 offset:4096
    ds_read_b64_tr_b16 a[218:219], v83 offset:6144
    v_mfma_f32_16x16x32_bf16 v[60:63], a[28:31], a[244:247], v[60:63]
    ds_read_b64_tr_b16 a[220:221], v84 offset:4096
    ds_read_b64_tr_b16 a[222:223], v84 offset:6144
    v_mfma_f32_16x16x32_bf16 v[64:67], a[28:31], a[248:251], v[64:67]
    buffer_load_dwordx4 a[8:11], v88, s[80:83], s14 offen offset:640 sc1
    v_mfma_f32_16x16x32_bf16 v[68:71], a[28:31], a[252:255], v[68:71]
    ds_read_b64_tr_b16 a[224:225], v81 offset:8192
    ds_read_b64_tr_b16 a[226:227], v81 offset:10240
    v_mfma_f32_16x16x32_bf16 v[56:59], a[32:35], a[64:67], v[56:59]
    s_waitcnt vmcnt(9)
    ds_read_b64_tr_b16 a[228:229], v82 offset:8192
    ds_read_b64_tr_b16 a[230:231], v82 offset:10240
    v_mfma_f32_16x16x32_bf16 v[60:63], a[32:35], a[68:71], v[60:63]
    ds_read_b64_tr_b16 a[232:233], v83 offset:8192
    ds_read_b64_tr_b16 a[234:235], v83 offset:10240
    v_mfma_f32_16x16x32_bf16 v[64:67], a[32:35], a[72:75], v[64:67]
    buffer_load_dwordx4 a[12:15], v88, s[80:83], s14 offen offset:768 sc1
    v_mfma_f32_16x16x32_bf16 v[68:71], a[32:35], a[76:79], v[68:71]
    ds_read_b64_tr_b16 a[236:237], v84 offset:8192
    ds_read_b64_tr_b16 a[238:239], v84 offset:10240
    v_mfma_f32_16x16x32_bf16 v[56:59], a[36:39], a[80:83], v[56:59]
    s_waitcnt vmcnt(9) lgkmcnt(15)
    ds_read_b64_tr_b16 a[240:241], v81 offset:12288
    ds_read_b64_tr_b16 a[242:243], v81 offset:14336
    v_mfma_f32_16x16x32_bf16 v[60:63], a[36:39], a[84:87], v[60:63]
    ds_read_b64_tr_b16 a[244:245], v82 offset:12288
    ds_read_b64_tr_b16 a[246:247], v82 offset:14336
    v_mfma_f32_16x16x32_bf16 v[64:67], a[36:39], a[88:91], v[64:67]
    s_addk_i32 s14, 0x2000
    buffer_load_dwordx4 a[16:19], v88, s[80:83], s14 offen offset:0 sc1
    v_mfma_f32_16x16x32_bf16 v[68:71], a[36:39], a[92:95], v[68:71]
    ds_read_b64_tr_b16 a[248:249], v83 offset:12288
    ds_read_b64_tr_b16 a[250:251], v83 offset:14336
    v_mfma_f32_16x16x32_bf16 v[56:59], a[40:43], a[96:99], v[56:59]
    s_waitcnt vmcnt(9)
    ds_read_b64_tr_b16 a[252:253], v84 offset:12288
    ds_read_b64_tr_b16 a[254:255], v84 offset:14336
    v_mfma_f32_16x16x32_bf16 v[60:63], a[40:43], a[100:103], v[60:63]
    ds_read_b64_tr_b16 a[64:65], v81 offset:16384
    ds_read_b64_tr_b16 a[66:67], v81 offset:18432
    v_mfma_f32_16x16x32_bf16 v[64:67], a[40:43], a[104:107], v[64:67]
    buffer_load_dwordx4 a[20:23], v88, s[80:83], s14 offen offset:128 sc1
    v_mfma_f32_16x16x32_bf16 v[68:71], a[40:43], a[108:111], v[68:71]
    ds_read_b64_tr_b16 a[68:69], v82 offset:16384
    ds_read_b64_tr_b16 a[70:71], v82 offset:18432
    v_mfma_f32_16x16x32_bf16 v[56:59], a[44:47], a[112:115], v[56:59]
    s_waitcnt vmcnt(9)
    ds_read_b64_tr_b16 a[72:73], v83 offset:16384
    ds_read_b64_tr_b16 a[74:75], v83 offset:18432
    v_mfma_f32_16x16x32_bf16 v[60:63], a[44:47], a[116:119], v[60:63]
    ds_read_b64_tr_b16 a[76:77], v84 offset:16384
    ds_read_b64_tr_b16 a[78:79], v84 offset:18432
    v_mfma_f32_16x16x32_bf16 v[64:67], a[44:47], a[120:123], v[64:67]
    buffer_load_dwordx4 a[24:27], v88, s[80:83], s14 offen offset:256 sc1
    v_mfma_f32_16x16x32_bf16 v[68:71], a[44:47], a[124:127], v[68:71]
    ds_read_b64_tr_b16 a[80:81], v81 offset:20480
    ds_read_b64_tr_b16 a[82:83], v81 offset:22528
    v_mfma_f32_16x16x32_bf16 v[56:59], a[48:51], a[128:131], v[56:59]
    s_waitcnt vmcnt(9)
    ds_read_b64_tr_b16 a[84:85], v82 offset:20480
    ds_read_b64_tr_b16 a[86:87], v82 offset:22528
    v_mfma_f32_16x16x32_bf16 v[60:63], a[48:51], a[132:135], v[60:63]
    ds_read_b64_tr_b16 a[88:89], v83 offset:20480
    ds_read_b64_tr_b16 a[90:91], v83 offset:22528
    v_mfma_f32_16x16x32_bf16 v[64:67], a[48:51], a[136:139], v[64:67]
    buffer_load_dwordx4 a[28:31], v88, s[80:83], s14 offen offset:512 sc1
    v_mfma_f32_16x16x32_bf16 v[68:71], a[48:51], a[140:143], v[68:71]
    ds_read_b64_tr_b16 a[92:93], v84 offset:20480
    ds_read_b64_tr_b16 a[94:95], v84 offset:22528
    v_mfma_f32_16x16x32_bf16 v[56:59], a[52:55], a[144:147], v[56:59]
    s_waitcnt vmcnt(9)
    ds_read_b64_tr_b16 a[96:97], v81 offset:24576
    ds_read_b64_tr_b16 a[98:99], v81 offset:26624
    v_mfma_f32_16x16x32_bf16 v[60:63], a[52:55], a[148:151], v[60:63]
    ds_read_b64_tr_b16 a[100:101], v82 offset:24576
    ds_read_b64_tr_b16 a[102:103], v82 offset:26624
    v_mfma_f32_16x16x32_bf16 v[64:67], a[52:55], a[152:155], v[64:67]
    buffer_load_dwordx4 a[32:35], v88, s[80:83], s14 offen offset:640 sc1
    v_mfma_f32_16x16x32_bf16 v[68:71], a[52:55], a[156:159], v[68:71]
    ds_read_b64_tr_b16 a[104:105], v83 offset:24576
    ds_read_b64_tr_b16 a[106:107], v83 offset:26624
    v_mfma_f32_16x16x32_bf16 v[56:59], a[56:59], a[160:163], v[56:59]
    s_waitcnt vmcnt(9)
    ds_read_b64_tr_b16 a[108:109], v84 offset:24576
    ds_read_b64_tr_b16 a[110:111], v84 offset:26624
    v_mfma_f32_16x16x32_bf16 v[60:63], a[56:59], a[164:167], v[60:63]
    ds_read_b64_tr_b16 a[112:113], v81 offset:28672
    ds_read_b64_tr_b16 a[114:115], v81 offset:30720
    v_mfma_f32_16x16x32_bf16 v[64:67], a[56:59], a[168:171], v[64:67]
    buffer_load_dwordx4 a[36:39], v88, s[80:83], s14 offen offset:768 sc1
    v_mfma_f32_16x16x32_bf16 v[68:71], a[56:59], a[172:175], v[68:71]
    ds_read_b64_tr_b16 a[116:117], v82 offset:28672
    ds_read_b64_tr_b16 a[118:119], v82 offset:30720
    v_mfma_f32_16x16x32_bf16 v[56:59], a[60:63], a[176:179], v[56:59]
    s_waitcnt vmcnt(9)
    ds_read_b64_tr_b16 a[120:121], v83 offset:28672
    ds_read_b64_tr_b16 a[122:123], v83 offset:30720
    v_mfma_f32_16x16x32_bf16 v[60:63], a[60:63], a[180:183], v[60:63]
    ds_read_b64_tr_b16 a[124:125], v84 offset:28672
    ds_read_b64_tr_b16 a[126:127], v84 offset:30720
    v_mfma_f32_16x16x32_bf16 v[64:67], a[60:63], a[184:187], v[64:67]
    s_addk_i32 s14, 0x2000
    buffer_load_dwordx4 a[40:43], v88, s[80:83], s14 offen offset:0 sc1
    v_mfma_f32_16x16x32_bf16 v[68:71], a[60:63], a[188:191], v[68:71]
    v_add_u32 v81, 0xfffe0000, v81
    v_add_u32 v82, 0xfffe0000, v82
    v_mfma_f32_16x16x32_bf16 v[112:115], a[0:3], a[192:195], 0
    s_waitcnt vmcnt(9) lgkmcnt(15)
    v_add_u32 v83, 0xfffe0000, v83
    v_add_u32 v84, 0xfffe0000, v84
    v_mfma_f32_16x16x32_bf16 v[116:119], a[0:3], a[196:199], 0
    ds_read_b64_tr_b16 a[128:129], v81 offset:0
    ds_read_b64_tr_b16 a[130:131], v81 offset:2048
    v_mfma_f32_16x16x32_bf16 v[120:123], a[0:3], a[200:203], 0
    buffer_load_dwordx4 a[44:47], v88, s[80:83], s14 offen offset:128 sc1
    v_mfma_f32_16x16x32_bf16 v[124:127], a[0:3], a[204:207], 0
    ds_read_b64_tr_b16 a[132:133], v82 offset:0
    ds_read_b64_tr_b16 a[134:135], v82 offset:2048
    v_mfma_f32_16x16x32_bf16 v[112:115], a[4:7], a[208:211], v[112:115]
    s_waitcnt vmcnt(9)
    ds_read_b64_tr_b16 a[136:137], v83 offset:0
    ds_read_b64_tr_b16 a[138:139], v83 offset:2048
    v_mfma_f32_16x16x32_bf16 v[116:119], a[4:7], a[212:215], v[116:119]
    ds_read_b64_tr_b16 a[140:141], v84 offset:0
    ds_read_b64_tr_b16 a[142:143], v84 offset:2048
    v_mfma_f32_16x16x32_bf16 v[120:123], a[4:7], a[216:219], v[120:123]
    buffer_load_dwordx4 a[48:51], v88, s[80:83], s14 offen offset:256 sc1
    v_mfma_f32_16x16x32_bf16 v[124:127], a[4:7], a[220:223], v[124:127]
    ds_read_b64_tr_b16 a[144:145], v81 offset:4096
    ds_read_b64_tr_b16 a[146:147], v81 offset:6144
    v_mfma_f32_16x16x32_bf16 v[112:115], a[8:11], a[224:227], v[112:115]
    s_waitcnt vmcnt(9)
    ds_read_b64_tr_b16 a[148:149], v82 offset:4096
    ds_read_b64_tr_b16 a[150:151], v82 offset:6144
    v_mfma_f32_16x16x32_bf16 v[116:119], a[8:11], a[228:231], v[116:119]
    ds_read_b64_tr_b16 a[152:153], v83 offset:4096
    ds_read_b64_tr_b16 a[154:155], v83 offset:6144
    v_mfma_f32_16x16x32_bf16 v[120:123], a[8:11], a[232:235], v[120:123]
    buffer_load_dwordx4 a[52:55], v88, s[80:83], s14 offen offset:512 sc1
    v_mfma_f32_16x16x32_bf16 v[124:127], a[8:11], a[236:239], v[124:127]
    ds_read_b64_tr_b16 a[156:157], v84 offset:4096
    ds_read_b64_tr_b16 a[158:159], v84 offset:6144
    v_mfma_f32_16x16x32_bf16 v[112:115], a[12:15], a[240:243], v[112:115]
    s_waitcnt vmcnt(9)
    ds_read_b64_tr_b16 a[160:161], v81 offset:8192
    ds_read_b64_tr_b16 a[162:163], v81 offset:10240
    v_mfma_f32_16x16x32_bf16 v[116:119], a[12:15], a[244:247], v[116:119]
    ds_read_b64_tr_b16 a[164:165], v82 offset:8192
    ds_read_b64_tr_b16 a[166:167], v82 offset:10240
    v_mfma_f32_16x16x32_bf16 v[120:123], a[12:15], a[248:251], v[120:123]
    buffer_load_dwordx4 a[56:59], v88, s[80:83], s14 offen offset:640 sc1
    v_mfma_f32_16x16x32_bf16 v[124:127], a[12:15], a[252:255], v[124:127]
    ds_read_b64_tr_b16 a[168:169], v83 offset:8192
    ds_read_b64_tr_b16 a[170:171], v83 offset:10240
    v_mfma_f32_16x16x32_bf16 v[112:115], a[16:19], a[64:67], v[112:115]
    s_waitcnt vmcnt(9)
    ds_read_b64_tr_b16 a[172:173], v84 offset:8192
    ds_read_b64_tr_b16 a[174:175], v84 offset:10240
    v_mfma_f32_16x16x32_bf16 v[116:119], a[16:19], a[68:71], v[116:119]
    ds_read_b64_tr_b16 a[176:177], v81 offset:12288
    ds_read_b64_tr_b16 a[178:179], v81 offset:14336
    v_mfma_f32_16x16x32_bf16 v[120:123], a[16:19], a[72:75], v[120:123]
    buffer_load_dwordx4 a[60:63], v88, s[80:83], s14 offen offset:768 sc1
    v_mfma_f32_16x16x32_bf16 v[124:127], a[16:19], a[76:79], v[124:127]
    ds_read_b64_tr_b16 a[180:181], v82 offset:12288
    ds_read_b64_tr_b16 a[182:183], v82 offset:14336
    v_mfma_f32_16x16x32_bf16 v[112:115], a[20:23], a[80:83], v[112:115]
    s_waitcnt vmcnt(9) lgkmcnt(15)
    ds_read_b64_tr_b16 a[184:185], v83 offset:12288
    v_mfma_f32_16x16x32_bf16 v[116:119], a[20:23], a[84:87], v[116:119]
    ds_read_b64_tr_b16 a[186:187], v83 offset:14336
    ds_read_b64_tr_b16 a[188:189], v84 offset:12288
    v_mfma_f32_16x16x32_bf16 v[120:123], a[20:23], a[88:91], v[120:123]
    ds_read_b64_tr_b16 a[190:191], v84 offset:14336
    v_sub_f32 v12, 1.0, v160
    v_mfma_f32_16x16x32_bf16 v[124:127], a[20:23], a[92:95], v[124:127]
    ds_read_b64_tr_b16 a[192:193], v81 offset:16384
    ds_read_b64_tr_b16 a[194:195], v81 offset:18432
    v_mfma_f32_16x16x32_bf16 v[112:115], a[24:27], a[96:99], v[112:115]
    s_waitcnt vmcnt(8)
    ds_read_b64_tr_b16 a[196:197], v82 offset:16384
    v_mfma_f32_16x16x32_bf16 v[116:119], a[24:27], a[100:103], v[116:119]
    ds_read_b64_tr_b16 a[198:199], v82 offset:18432
    ds_read_b64_tr_b16 a[200:201], v83 offset:16384
    v_mfma_f32_16x16x32_bf16 v[120:123], a[24:27], a[104:107], v[120:123]
    ds_read_b64_tr_b16 a[202:203], v83 offset:18432
    v_sub_f32 v13, 1.0, v161
    v_mfma_f32_16x16x32_bf16 v[124:127], a[24:27], a[108:111], v[124:127]
    ds_read_b64_tr_b16 a[204:205], v84 offset:16384
    ds_read_b64_tr_b16 a[206:207], v84 offset:18432
    v_mfma_f32_16x16x32_bf16 v[112:115], a[28:31], a[112:115], v[112:115]
    s_waitcnt vmcnt(7)
    ds_read_b64_tr_b16 a[208:209], v81 offset:20480
    v_mfma_f32_16x16x32_bf16 v[116:119], a[28:31], a[116:119], v[116:119]
    ds_read_b64_tr_b16 a[210:211], v81 offset:22528
    ds_read_b64_tr_b16 a[212:213], v82 offset:20480
    v_mfma_f32_16x16x32_bf16 v[120:123], a[28:31], a[120:123], v[120:123]
    ds_read_b64_tr_b16 a[214:215], v82 offset:22528
    v_sub_f32 v14, 1.0, v162
    v_mfma_f32_16x16x32_bf16 v[124:127], a[28:31], a[124:127], v[124:127]
    ds_read_b64_tr_b16 a[216:217], v83 offset:20480
    ds_read_b64_tr_b16 a[218:219], v83 offset:22528
    v_mfma_f32_16x16x32_bf16 v[112:115], a[32:35], a[128:131], v[112:115]
    s_waitcnt vmcnt(6) lgkmcnt(15)
    ds_read_b64_tr_b16 a[220:221], v84 offset:20480
    v_mfma_f32_16x16x32_bf16 v[116:119], a[32:35], a[132:135], v[116:119]
    ds_read_b64_tr_b16 a[222:223], v84 offset:22528
    ds_read_b64_tr_b16 a[224:225], v81 offset:24576
    v_mfma_f32_16x16x32_bf16 v[120:123], a[32:35], a[136:139], v[120:123]
    ds_read_b64_tr_b16 a[226:227], v81 offset:26624
    v_sub_f32 v15, 1.0, v163
    v_mfma_f32_16x16x32_bf16 v[124:127], a[32:35], a[140:143], v[124:127]
    ds_read_b64_tr_b16 a[228:229], v82 offset:24576
    ds_read_b64_tr_b16 a[230:231], v82 offset:26624
    v_mfma_f32_16x16x32_bf16 v[112:115], a[36:39], a[144:147], v[112:115]
    s_waitcnt vmcnt(5)
    ds_read_b64_tr_b16 a[232:233], v83 offset:24576
    v_mfma_f32_16x16x32_bf16 v[116:119], a[36:39], a[148:151], v[116:119]
    ds_read_b64_tr_b16 a[234:235], v83 offset:26624
    ds_read_b64_tr_b16 a[236:237], v84 offset:24576
    v_mfma_f32_16x16x32_bf16 v[120:123], a[36:39], a[152:155], v[120:123]
    ds_read_b64_tr_b16 a[238:239], v84 offset:26624
    v_mul_f32 v56, v160, v56
    v_mfma_f32_16x16x32_bf16 v[124:127], a[36:39], a[156:159], v[124:127]
    ds_read_b64_tr_b16 a[240:241], v81 offset:28672
    ds_read_b64_tr_b16 a[242:243], v81 offset:30720
    v_mfma_f32_16x16x32_bf16 v[112:115], a[40:43], a[160:163], v[112:115]
    s_waitcnt vmcnt(4) lgkmcnt(15)
    ds_read_b64_tr_b16 a[244:245], v82 offset:28672
    v_mfma_f32_16x16x32_bf16 v[116:119], a[40:43], a[164:167], v[116:119]
    ds_read_b64_tr_b16 a[246:247], v82 offset:30720
    ds_read_b64_tr_b16 a[248:249], v83 offset:28672
    v_mfma_f32_16x16x32_bf16 v[120:123], a[40:43], a[168:171], v[120:123]
    ds_read_b64_tr_b16 a[250:251], v83 offset:30720
    v_mul_f32 v57, v161, v57
    v_mfma_f32_16x16x32_bf16 v[124:127], a[40:43], a[172:175], v[124:127]
    ds_read_b64_tr_b16 a[252:253], v84 offset:28672
    ds_read_b64_tr_b16 a[254:255], v84 offset:30720
    v_mfma_f32_16x16x32_bf16 v[112:115], a[44:47], a[176:179], v[112:115]
    s_waitcnt vmcnt(3)
    v_mul_f32 v58, v162, v58
    v_mfma_f32_16x16x32_bf16 v[116:119], a[44:47], a[180:183], v[116:119]
    v_mul_f32 v59, v163, v59
    v_mul_f32 v60, v160, v60
    v_mfma_f32_16x16x32_bf16 v[120:123], a[44:47], a[184:187], v[120:123]
    v_mul_f32 v61, v161, v61
    v_mul_f32 v62, v162, v62
    v_mfma_f32_16x16x32_bf16 v[124:127], a[44:47], a[188:191], v[124:127]
    v_mul_f32 v63, v163, v63
    v_mul_f32 v64, v160, v64
    s_mov_b32 s41, 0x8000
    v_mfma_f32_16x16x32_bf16 v[112:115], a[48:51], a[192:195], v[112:115]
    v_mul_f32 v65, v161, v65
    v_mul_f32 v66, v162, v66
    s_waitcnt vmcnt(2)
    v_mfma_f32_16x16x32_bf16 v[112:115], a[52:55], a[208:211], v[112:115]
    v_mul_f32 v67, v163, v67
    v_mul_f32 v68, v160, v68
    s_waitcnt vmcnt(1) lgkmcnt(14)
    v_mfma_f32_16x16x32_bf16 v[112:115], a[56:59], a[224:227], v[112:115]
    v_mul_f32 v69, v161, v69
    v_mul_f32 v70, v162, v70
    s_waitcnt vmcnt(0) lgkmcnt(6)
    v_mfma_f32_16x16x32_bf16 v[112:115], a[60:63], a[240:243], v[112:115]
    v_mul_f32 v71, v163, v71
    v_mfma_f32_16x16x32_bf16 v[116:119], a[48:51], a[196:199], v[116:119]
    v_mfma_f32_16x16x32_bf16 v[116:119], a[52:55], a[212:215], v[116:119]
    v_mfma_f32_16x16x32_bf16 v[116:119], a[56:59], a[228:231], v[116:119]
    s_nop 3
    v_fmac_f32 v56, v112, v12
    v_fmac_f32 v57, v113, v13
    s_waitcnt lgkmcnt(4)
    v_mfma_f32_16x16x32_bf16 v[116:119], a[60:63], a[244:247], v[116:119]
    v_fmac_f32 v58, v114, v14
    v_fmac_f32 v59, v115, v15
    v_mfma_f32_16x16x32_bf16 v[120:123], a[48:51], a[200:203], v[120:123]
    buffer_store_dword v56, v44, s[84:87], 0 offen offset:0 nt
    buffer_store_dword v57, v44, s[84:87], s41 offen offset:0 nt
    v_mfma_f32_16x16x32_bf16 v[120:123], a[52:55], a[216:219], v[120:123]
    buffer_store_dword v58, v44, s[84:87], 0 offen offset:2048 nt
    buffer_store_dword v59, v44, s[84:87], s41 offen offset:2048 nt
    v_mfma_f32_16x16x32_bf16 v[120:123], a[56:59], a[232:235], v[120:123]
    v_fmac_f32 v60, v116, v12
    v_fmac_f32 v61, v117, v13
    s_waitcnt lgkmcnt(2)
    v_mfma_f32_16x16x32_bf16 v[120:123], a[60:63], a[248:251], v[120:123]
    v_fmac_f32 v62, v118, v14
    v_fmac_f32 v63, v119, v15
    v_mfma_f32_16x16x32_bf16 v[124:127], a[48:51], a[204:207], v[124:127]
    buffer_store_dword v60, v44, s[84:87], 0 offen offset:64 nt
    buffer_store_dword v61, v44, s[84:87], s41 offen offset:64 nt
    v_mfma_f32_16x16x32_bf16 v[124:127], a[52:55], a[220:223], v[124:127]
    buffer_store_dword v62, v44, s[84:87], 0 offen offset:2112 nt
    buffer_store_dword v63, v44, s[84:87], s41 offen offset:2112 nt
    v_mfma_f32_16x16x32_bf16 v[124:127], a[56:59], a[236:239], v[124:127]
    v_fmac_f32 v64, v120, v12
    v_fmac_f32 v65, v121, v13
    s_waitcnt lgkmcnt(0)
    v_mfma_f32_16x16x32_bf16 v[124:127], a[60:63], a[252:255], v[124:127]
    v_fmac_f32 v66, v122, v14
    v_fmac_f32 v67, v123, v15
    buffer_store_dword v64, v44, s[84:87], 0 offen offset:128 nt
    buffer_store_dword v65, v44, s[84:87], s41 offen offset:128 nt
    buffer_store_dword v66, v44, s[84:87], 0 offen offset:2176 nt
    buffer_store_dword v67, v44, s[84:87], s41 offen offset:2176 nt
    s_nop 1
    v_fmac_f32 v68, v124, v12
    v_fmac_f32 v69, v125, v13
    v_fmac_f32 v70, v126, v14
    v_fmac_f32 v71, v127, v15
    buffer_store_dword v68, v44, s[84:87], 0 offen offset:192 nt
    buffer_store_dword v69, v44, s[84:87], s41 offen offset:192 nt
    buffer_store_dword v70, v44, s[84:87], 0 offen offset:2240 nt
    buffer_store_dword v71, v44, s[84:87], s41 offen offset:2240 nt
    s_endpgm
.p2align 12
L_typeX:

    s_mov_b32 s82, 0xa00000
    s_mov_b32 s83, 0x20000
    s_mov_b64 s[80:81], s[34:35]
    s_mov_b32 s86, 0x400000
    s_mov_b32 s87, 0x20000
    s_mov_b64 s[84:85], s[30:31]
    s_mov_b32 s90, 0x80000
    s_mov_b32 s91, 0x20000
    s_mov_b64 s[88:89], s[14:15]
    s_mov_b32 s10, 0x80800
    s_mov_b32 s11, 0x20000
    s_sub_u32 s8, s16, 2048
    s_subb_u32 s9, s17, 0
    s_mov_b32 s6, 0x80000
    s_mov_b32 s7, 0x20000
    s_mov_b64 s[4:5], s[26:27]
    s_bitcmp1_b32 s2, 7
    s_cselect_b64 s[96:97], s[16:17], s[14:15]
    s_and_b32 s41, s2, 1
    s_lshl1_add_u32 s52, s52, s41
    s_lshl_b32 s52, s52, 9
    s_lshl2_add_u32 s22, s39, s3
    s_lshl_b32 s22, s22, 14
    s_lshl_b32 s23, s39, 7
    s_lshl_b32 s41, s3, 15
    s_add_u32 s23, s23, s41
    v_xor_b32 v6, 64, v19
    v_add_u32 v20, 7168, v6
    v_and_b32 v5, 6, v8
    v_xor_b32 v5, v5, v9
    v_lshlrev_b32 v5, 4, v5
    v_lshl_add_u32 v21, v8, 10, v5
    s_add_u32 m0, s47, 0x4000
    s_nop 0
    buffer_load_dwordx4 v17, s[60:63], s48 offen lds
    v_lshrrev_b32 v4, 1, v2
    v_xor_b32 v4, v4, v3
    v_lshlrev_b32 v4, 4, v4
    v_lshl_add_u32 v30, v2, 7, v4
    v_xor_b32 v31, 64, v30
    v_add_u32 v32, 0x10000, v30
    v_add_u32 v33, 0x10000, v31
    s_lshl_b32 s41, s40, 11
    v_add_u32 v34, s41, v30
    v_add_u32 v35, s41, v31
    v_add_u32 v36, s41, v32
    v_add_u32 v37, s41, v33
    s_mul_i32 s50, s3, 49152
    s_add_u32 s50, s50, s46
    s_xor_b32 s50, s50, 0
    v_and_b32 v4, 1, v3
    buffer_load_dwordx4 v18, s[60:63], s48 offen offset:1024 lds
    v_lshrrev_b32 v5, 2, v2
    v_lshl_add_u32 v5, v4, 3, v5
    v_lshrrev_b32 v6, 3, v2
    v_lshl_add_u32 v6, v4, 1, v6
    v_lshlrev_b32 v6, 1, v6
    v_bfe_u32 v7, v2, 1, 1
    v_xor_b32 v6, v6, v7
    v_lshlrev_b32 v6, 4, v6
    v_lshl_add_u32 v6, v5, 7, v6
    v_and_b32 v7, 1, v2
    v_lshl_add_u32 v6, v7, 3, v6
    v_lshrrev_b32 v7, 1, v3
    s_lshl_b32 s41, s3, 5
    v_xor_b32 v5, s41, v6
    v_lshl_add_u32 v38, v7, 12, v5
    v_add_u32 v39, 0x10000, v38
    buffer_load_dwordx4 v17, s[64:67], s48 offen offset:2048 lds
    v_lshl_add_u32 v40, v7, 11, v6
    v_xor_b32 v41, 32, v40
    v_xor_b32 v42, 64, v40
    v_xor_b32 v43, 96, v40
    v_xor_b32 v44, 0x2000, v34
    v_xor_b32 v45, 0x2000, v35
    v_xor_b32 v46, 0x2000, v36
    v_xor_b32 v47, 0x2000, v37
    v_lshlrev_b32 v48, 4, v3
    v_add_u32 v48, 0x20000, v48
    s_lshl_b32 s41, s39, 7
    s_add_u32 s41, s41, 0x20400
    v_lshl_add_u32 v49, v2, 1, s41
    v_mov_b32 v76, 0
    v_mov_b32 v77, 0
    v_mov_b32 v78, 0
    buffer_load_dwordx4 v18, s[64:67], s48 offen offset:3072 lds
    v_mov_b32 v79, 0
    v_mov_b32 v60, 0
    v_mov_b32 v61, 0
    v_mov_b32 v62, 0
    v_mov_b32 v63, 0
    v_mov_b32 v64, 0
    v_mov_b32 v65, 0
    v_mov_b32 v66, 0
    v_mov_b32 v67, 0
    v_mov_b32 v68, 0
    v_mov_b32 v69, 0
    v_mov_b32 v70, 0
    v_mov_b32 v71, 0
    v_mov_b32 v72, 0
    v_mov_b32 v73, 0
    v_mov_b32 v74, 0
    s_lshr_b32 s44, s47, 2
    s_add_u32 m0, s44, 0x20000
    s_cmp_lt_u32 s3, 2
    s_cbranch_scc0 LX_pf_3
    buffer_load_dwordx4 v10, s[72:75], 0 offen lds
LX_pf_3:
    s_load_dword s43, s[80:81], 0x0
    v_mov_b32 v75, 0
    s_add_u32 s42, s47, 0x24000
    v_lshrrev_b32 v4, 3, v2
    v_lshlrev_b32 v5, 1, v3
    v_xor_b32 v4, v4, v5
    v_lshlrev_b32 v4, 4, v4
    v_lshl_add_u32 v4, v3, 9, v4
    v_and_b32 v5, 7, v2
    v_lshl_add_u32 v4, v5, 1, v4
    v_add_u32 v51, s42, v4
    v_xor_b32 v52, 16, v51
    v_xor_b32 v53, 32, v51
    v_xor_b32 v54, 48, v51
    v_xor_b32 v55, 64, v51
    v_xor_b32 v56, 80, v51
    v_xor_b32 v57, 96, v51
    s_add_u32 m0, s47, 0x8000
    s_addk_i32 s45, 0x80
    buffer_load_dwordx4 v11, s[56:59], s45 offen lds
    v_xor_b32 v58, 112, v51
    s_lshl_b32 s42, s36, 7
    s_lshl1_add_u32 s42, s40, s42
    v_lshl_add_u32 v4, v3, 5, s42
    s_lshl_b32 s42, s39, 6
    v_add_u32 v5, s42, v2
    v_lshlrev_b32 v5, 2, v5
    v_lshl_add_u32 v50, v4, 11, v5
    v_lshlrev_b32 v98, 4, v9
    v_lshl_add_u32 v98, v8, 10, v98
    v_lshlrev_b32 v95, 2, v1
    v_lshlrev_b32 v99, 9, v1
    v_lshlrev_b32 v100, 13, v1
    s_mov_b32 s12, -1
    s_mov_b32 s13, 0
    s_lshl_b32 s16, s36, 13
    buffer_load_dwordx4 v16, s[56:59], s45 offen offset:1024 lds
    s_add_u32 s16, s16, 0x20000
    s_lshl_b32 s17, s38, 10
    s_add_u32 s15, s16, s17
    s_add_u32 s15, s15, 512
    s_mov_b32 s42, s38
    s_lshl2_add_u32 s16, s42, s16
    s_mul_i32 s18, s3, 0
    s_add_u32 s18, s18, s15
    s_lshl2_add_u32 s17, s36, s17
    s_add_u32 s17, s17, 0x20200
    s_lshl_b32 s44, s3, 7
    s_add_u32 s44, s44, s15
    v_mov_b32 v101, 0
    s_mov_b64 exec, 1
    buffer_atomic_add v101, v95, s[80:83], s44 offen sc1
    s_mov_b64 exec, -1
    v_lshrrev_b32 v4, 1, v2
    v_lshrrev_b32 v5, 1, v3
    v_xor_b32 v4, v4, v5
    v_lshlrev_b32 v4, 4, v4
    v_lshl_add_u32 v4, v2, 7, v4
    buffer_load_dwordx4 v11, s[56:59], s45 offen offset:2048 lds
    v_and_b32 v5, 1, v3
    v_lshl_add_u32 v59, v5, 11, v4
    v_xor_b32 v80, 32, v59
    v_xor_b32 v81, 64, v59
    v_xor_b32 v82, 96, v59
    v_add_u32 v83, 0x10000, v59
    v_add_u32 v84, 0x10000, v80
    v_add_u32 v85, 0x10000, v81
    v_add_u32 v86, 0x10000, v82
    v_add_u32 v87, 0x20000, v59
    v_add_u32 v88, 0x20000, v80
    v_add_u32 v89, 0x20000, v81
    v_add_u32 v90, 0x20000, v82
    v_lshrrev_b32 v4, 2, v2
    v_lshl_add_u32 v4, v3, 2, v4
    v_and_b32 v5, 6, v4
    buffer_load_dwordx4 v16, s[56:59], s45 offen offset:3072 lds
    v_bfe_u32 v6, v2, 1, 1
    v_xor_b32 v5, v5, v6
    v_lshlrev_b32 v5, 4, v5
    v_lshl_add_u32 v5, v4, 7, v5
    v_and_b32 v6, 1, v2
    v_lshl_add_u32 v5, v6, 3, v5
    v_add_u32 v91, 0x8000, v5
    v_xor_b32 v92, 32, v91
    v_xor_b32 v93, 64, v91
    v_xor_b32 v94, 96, v91
    s_lshl3_add_u32 s14, s36, s40
    s_lshl_b32 s14, s14, 16
    s_add_u32 s14, s14, 0x200000
    v_mov_b32 v172, 0x3fb8aa3b
    v_mov_b32 v173, 0x358637bd
    v_mov_b32 v176, 0x3f803f80
    s_addk_i32 m0, 0x4000
    s_add_u32 s48, s48, s49
    buffer_load_dwordx4 v17, s[60:63], s48 offen lds
    v_mov_b32 v177, 0x3f803f80
    v_mov_b32 v178, 0x3f803f80
    v_mov_b32 v179, 0x3f803f80
    v_mov_b32 v180, 0x358637bd
    v_mov_b32 v181, 0x358637bd
    v_mov_b32 v182, 0x358637bd
    v_mov_b32 v183, 0x358637bd
    s_mov_b32 s24, 0x22222222
    s_mov_b32 s25, 0x22222222
    s_mov_b32 s26, 0x44444444
    s_mov_b32 s27, 0x44444444
    s_mov_b32 s28, 0x88888888
    s_mov_b32 s29, 0x88888888
    s_lshl2_add_u32 s42, s38, s3
    s_lshl_b32 s31, s42, 15
    s_add_u32 s31, s31, 0x40000
    buffer_load_dwordx4 v18, s[60:63], s48 offen offset:1024 lds
    s_lshl_b32 s30, s36, 11
    s_add_u32 s30, s30, s31
    s_lshl_b32 s32, s36, 6
    s_lshl1_add_u32 s31, s32, s31
    s_lshl_b32 s42, s42, 10
    s_add_u32 s32, s32, s42
    s_lshl_b32 s32, s32, 0
    s_add_u32 s32, s32, 0x140000
    s_xor_b32 s33, s38, 0
    s_lshl_b32 s33, s33, 12
    s_add_u32 s33, s33, 0x140000
    s_add_u32 s19, s31, 0x4000
    v_lshrrev_b32 v174, 2, v1
    v_lshlrev_b32 v174, 11, v174
    v_and_b32 v7, 48, v10
    v_lshrrev_b32 v175, 4, v174
    buffer_load_dwordx4 v17, s[64:67], s48 offen offset:2048 lds
    v_add_u32 v175, v175, v7
    v_add_u32 v174, v174, v7
    s_xor_b32 s42, s38, 0
    s_lshl1_add_u32 s42, s42, 32
    s_mul_i32 s41, s42, 43
    s_lshr_b32 s41, s41, 8
    s_mul_i32 s44, s41, 6
    s_sub_u32 s44, s42, s44
    s_cmp_ge_u32 s44, 3
    s_addc_u32 s44, s44, 0
    s_lshl_b32 s41, s41, 6
    s_add_u32 s41, s41, s44
    s_lshl_b32 s34, s41, 7
    s_add_u32 s42, s42, 1
    s_mul_i32 s41, s42, 43
    s_lshr_b32 s41, s41, 8
    s_mul_i32 s44, s41, 6
    s_sub_u32 s44, s42, s44
    s_cmp_ge_u32 s44, 3
    s_addc_u32 s44, s44, 0
    s_lshl_b32 s41, s41, 6
    s_add_u32 s41, s41, s44
    s_lshl_b32 s35, s41, 7
    s_add_u32 s34, s34, s14
    s_add_u32 s35, s35, s14
    s_xor_b32 s77, s34, 0x40000
    s_xor_b32 s78, s35, 0x40000
    v_lshlrev_b32 v174, 4, v9
    v_lshl_add_u32 v174, v8, 11, v174
    buffer_load_dwordx4 v18, s[64:67], s48 offen offset:3072 lds
    s_and_b32 s44, s76, 48
    s_cbranch_scc0 LX_pf_4
    s_add_u32 m0, s47, 0x24000
    global_load_dwordx4 v[12:15], v24, s[68:69] offset:1024
    global_load_dwordx4 v[12:15], v29, s[0:1]
    buffer_load_dwordx4 v11, s[56:59], s51 offen lds
    buffer_load_dwordx4 v16, s[56:59], s51 offen offset:1024 lds
    buffer_load_dwordx4 v[12:15], v22, s[68:71], 0 offen offset:1408
    s_add_u32 m0, s47, 0xc000
    s_nop 0
LX_pf_4:
    s_waitcnt vmcnt(9)
    s_barrier
    ds_read_b64_tr_b16 v[232:233], v38 offset:16384
    ds_read_b64_tr_b16 v[234:235], v38 offset:16896
    ds_read_b64_tr_b16 v[236:237], v38 offset:18432
    ds_read_b64_tr_b16 v[238:239], v38 offset:18944
    s_addk_i32 m0, 0x4000
    s_addk_i32 s45, 0x80
    buffer_load_dwordx4 v11, s[56:59], s45 offen lds
    ds_read_b128 a[192:195], v30 offset:0
    ds_read_b128 a[196:199], v30 offset:2048
    ds_read_b128 a[200:203], v30 offset:4096
    ds_read_b128 a[204:207], v30 offset:6144
    buffer_load_dwordx4 v16, s[56:59], s45 offen offset:1024 lds
    ds_read_b128 a[208:211], v30 offset:8192
    ds_read_b128 a[212:215], v30 offset:10240
    ds_read_b128 a[216:219], v30 offset:12288
    ds_read_b128 a[220:223], v30 offset:14336
    buffer_load_dwordx4 v11, s[56:59], s45 offen offset:2048 lds
    ds_read_b128 a[64:67], v34 offset:0
    ds_read_b128 a[128:131], v44 offset:0
    ds_read_b128 a[0:3], v48 offset:0
    ds_read_b128 a[4:7], v48 offset:64
    ds_read_b128 a[8:11], v48 offset:128
    ds_read_b128 a[12:15], v48 offset:192
    ds_read_b128 a[16:19], v48 offset:256
    ds_read_b128 a[20:23], v48 offset:320
    ds_read_b128 a[24:27], v48 offset:384
    ds_read_b128 a[28:31], v48 offset:448
    s_waitcnt lgkmcnt(0)
    v_mfma_f32_16x16x32_bf16 v[104:107], a[192:195], v[232:235], 1.0
    ds_read_b128 a[224:227], v31 offset:0
    ds_read_b128 a[228:231], v31 offset:2048
    v_mfma_f32_16x16x32_bf16 v[136:139], a[192:195], v[236:239], 0
    buffer_load_dwordx4 v16, s[56:59], s45 offen offset:3072 lds
    v_mfma_f32_16x16x32_bf16 v[108:111], a[196:199], v[232:235], 1.0
    ds_read_b128 a[232:235], v31 offset:4096
    ds_read_b128 a[236:239], v31 offset:6144
    v_mfma_f32_16x16x32_bf16 v[140:143], a[196:199], v[236:239], 0
    s_addk_i32 m0, 0x4000
    s_add_u32 s48, s48, s49
    buffer_load_dwordx4 v17, s[60:63], s48 offen lds
    v_mfma_f32_16x16x32_bf16 v[112:115], a[200:203], v[232:235], 1.0
    ds_read_b128 a[240:243], v31 offset:8192
    ds_read_b128 a[244:247], v31 offset:10240
    v_mfma_f32_16x16x32_bf16 v[144:147], a[200:203], v[236:239], 0
    buffer_load_dwordx4 v18, s[60:63], s48 offen offset:1024 lds
    v_mfma_f32_16x16x32_bf16 v[116:119], a[204:207], v[232:235], 1.0
    ds_read_b128 a[248:251], v31 offset:12288
    ds_read_b128 a[252:255], v31 offset:14336
    v_mfma_f32_16x16x32_bf16 v[148:151], a[204:207], v[236:239], 0
    ds_read_b64_tr_b16 v[240:241], v38 offset:24576
    v_mfma_f32_16x16x32_bf16 v[120:123], a[208:211], v[232:235], 1.0
    buffer_load_dwordx4 v17, s[64:67], s48 offen offset:2048 lds
    v_mfma_f32_16x16x32_bf16 v[152:155], a[208:211], v[236:239], 0
    ds_read_b64_tr_b16 v[242:243], v38 offset:25088
    ds_read_b64_tr_b16 v[244:245], v38 offset:26624
    v_mfma_f32_16x16x32_bf16 v[124:127], a[212:215], v[232:235], 1.0
    buffer_load_dwordx4 v18, s[64:67], s48 offen offset:3072 lds
    s_and_b32 s44, s76, 192
    s_cbranch_scc0 LX_pf_5
    s_add_u32 m0, s47, 0x24000
    global_load_dwordx4 v[12:15], v24, s[68:69] offset:1024
    global_load_dwordx4 v[12:15], v29, s[0:1]
    buffer_load_dwordx4 v11, s[56:59], s51 offen lds
    buffer_load_dwordx4 v16, s[56:59], s51 offen offset:1024 lds
    buffer_load_dwordx4 v[12:15], v22, s[68:71], 0 offen offset:1408
    s_add_u32 m0, s47, 0x14000
    s_nop 0
LX_pf_5:
    v_mfma_f32_16x16x32_bf16 v[156:159], a[212:215], v[236:239], 0
    ds_read_b64_tr_b16 v[246:247], v38 offset:27136
    ds_read_b128 a[68:71], v35 offset:0
    v_mfma_f32_16x16x32_bf16 v[128:131], a[216:219], v[232:235], 1.0
    s_addk_i32 m0, 0x4000
    s_addk_i32 s45, 0x80
    buffer_load_dwordx4 v11, s[56:59], s45 offen lds
    v_mfma_f32_16x16x32_bf16 v[160:163], a[216:219], v[236:239], 0
    ds_read_b128 a[132:135], v45 offset:0
    v_mfma_f32_16x16x32_bf16 v[132:135], a[220:223], v[232:235], 1.0
    v_mfma_f32_16x16x32_bf16 v[164:167], a[220:223], v[236:239], 0
    buffer_load_dwordx4 v16, s[56:59], s45 offen offset:1024 lds
    s_waitcnt vmcnt(10) lgkmcnt(0)
    s_barrier
    v_mfma_f32_16x16x32_bf16 v[104:107], a[224:227], v[240:243], v[104:107]
    ds_read_b64_tr_b16 v[232:233], v38 offset:49152
    ds_read_b64_tr_b16 v[234:235], v38 offset:49664
    v_mfma_f32_16x16x32_bf16 v[136:139], a[224:227], v[244:247], v[136:139]
    buffer_load_dwordx4 v11, s[56:59], s45 offen offset:2048 lds
    v_mfma_f32_16x16x32_bf16 v[108:111], a[228:231], v[240:243], v[108:111]
    ds_read_b64_tr_b16 v[236:237], v38 offset:51200
    ds_read_b64_tr_b16 v[238:239], v38 offset:51712
    v_mfma_f32_16x16x32_bf16 v[140:143], a[228:231], v[244:247], v[140:143]
    ds_read_b128 a[192:195], v30 offset:32768
    ds_read_b128 a[196:199], v30 offset:34816
    v_mfma_f32_16x16x32_bf16 v[112:115], a[232:235], v[240:243], v[112:115]
    ds_read_b128 a[200:203], v30 offset:36864
    ds_read_b128 a[204:207], v30 offset:38912
    v_mfma_f32_16x16x32_bf16 v[144:147], a[232:235], v[244:247], v[144:147]
    buffer_load_dwordx4 v16, s[56:59], s45 offen offset:3072 lds
    v_mfma_f32_16x16x32_bf16 v[116:119], a[236:239], v[240:243], v[116:119]
    ds_read_b128 a[208:211], v30 offset:40960
    ds_read_b128 a[212:215], v30 offset:43008
    v_mfma_f32_16x16x32_bf16 v[148:151], a[236:239], v[244:247], v[148:151]
    ds_read_b128 a[216:219], v30 offset:45056
    s_addk_i32 m0, 0x4000
    v_mfma_f32_16x16x32_bf16 v[120:123], a[240:243], v[240:243], v[120:123]
    ds_read_b128 a[220:223], v30 offset:47104
    s_add_u32 s48, s48, s49
    v_mfma_f32_16x16x32_bf16 v[152:155], a[240:243], v[244:247], v[152:155]
    buffer_load_dwordx4 v17, s[60:63], s48 offen lds
    v_mfma_f32_16x16x32_bf16 v[124:127], a[244:247], v[240:243], v[124:127]
    ds_read_b128 a[72:75], v34 offset:32768
    ds_read_b128 a[32:35], v48 offset:512
    v_mfma_f32_16x16x32_bf16 v[156:159], a[244:247], v[244:247], v[156:159]
    ds_read_b128 a[136:139], v44 offset:32768
    ds_read_b128 a[36:39], v48 offset:576
    v_mfma_f32_16x16x32_bf16 v[128:131], a[248:251], v[240:243], v[128:131]
    ds_read_b128 a[224:227], v31 offset:32768
    ds_read_b128 a[40:43], v48 offset:640
    v_mfma_f32_16x16x32_bf16 v[160:163], a[248:251], v[244:247], v[160:163]
    buffer_load_dwordx4 v18, s[60:63], s48 offen offset:1024 lds
    v_mfma_f32_16x16x32_bf16 v[132:135], a[252:255], v[240:243], v[132:135]
    ds_read_b128 a[228:231], v31 offset:34816
    ds_read_b128 a[44:47], v48 offset:704
    v_mfma_f32_16x16x32_bf16 v[164:167], a[252:255], v[244:247], v[164:167]
    ds_read_b128 a[232:235], v31 offset:36864
    s_waitcnt lgkmcnt(13)
    v_mfma_f32_16x16x32_bf16 v[104:107], a[192:195], v[232:235], v[104:107]
    ds_read_b128 a[236:239], v31 offset:38912
    ds_read_b128 a[48:51], v48 offset:768
    v_mfma_f32_16x16x32_bf16 v[136:139], a[192:195], v[236:239], v[136:139]
    buffer_load_dwordx4 v17, s[64:67], s48 offen offset:2048 lds
    v_mfma_f32_16x16x32_bf16 v[108:111], a[196:199], v[232:235], v[108:111]
    ds_read_b128 a[240:243], v31 offset:40960
    ds_read_b128 a[52:55], v48 offset:832
    v_mfma_f32_16x16x32_bf16 v[140:143], a[196:199], v[236:239], v[140:143]
    ds_read_b128 a[244:247], v31 offset:43008
    ds_read_b128 a[56:59], v48 offset:896
    v_mfma_f32_16x16x32_bf16 v[112:115], a[200:203], v[232:235], v[112:115]
    ds_read_b128 a[248:251], v31 offset:45056
    ds_read_b128 a[60:63], v48 offset:960
    v_mfma_f32_16x16x32_bf16 v[144:147], a[200:203], v[236:239], v[144:147]
    buffer_load_dwordx4 v18, s[64:67], s48 offen offset:3072 lds
    v_mfma_f32_16x16x32_bf16 v[116:119], a[204:207], v[232:235], v[116:119]
    ds_read_b128 a[252:255], v31 offset:47104
    s_mov_b32 m0, s47
    v_mfma_f32_16x16x32_bf16 v[148:151], a[204:207], v[236:239], v[148:151]
    ds_read_b64_tr_b16 v[240:241], v38 offset:57344
    s_waitcnt lgkmcnt(15)
    v_mfma_f32_16x16x32_bf16 v[120:123], a[208:211], v[232:235], v[120:123]
    ds_read_b64_tr_b16 v[242:243], v38 offset:57856
    ds_read_b64_tr_b16 v[244:245], v38 offset:59392
    v_mfma_f32_16x16x32_bf16 v[152:155], a[208:211], v[236:239], v[152:155]
    s_addk_i32 s45, 0x80
    buffer_load_dwordx4 v11, s[56:59], s45 offen lds
    v_mfma_f32_16x16x32_bf16 v[124:127], a[212:215], v[232:235], v[124:127]
    ds_read_b64_tr_b16 v[246:247], v38 offset:59904
    ds_read_b128 a[76:79], v35 offset:32768
    v_mfma_f32_16x16x32_bf16 v[156:159], a[212:215], v[236:239], v[156:159]
    ds_read_b128 a[140:143], v45 offset:32768
    ds_read_u16_d16_hi v76, v49 offset:0
    v_mfma_f32_16x16x32_bf16 v[128:131], a[216:219], v[232:235], v[128:131]
    v_mfma_f32_16x16x32_bf16 v[160:163], a[216:219], v[236:239], v[160:163]
    buffer_load_dwordx4 v16, s[56:59], s45 offen offset:1024 lds
    v_mfma_f32_16x16x32_bf16 v[132:135], a[220:223], v[232:235], v[132:135]
    v_mfma_f32_16x16x32_bf16 v[164:167], a[220:223], v[236:239], v[164:167]
    s_waitcnt vmcnt(10) lgkmcnt(0)
    s_barrier
    v_mfma_f32_16x16x32_bf16 v[104:107], a[224:227], v[240:243], v[104:107]
    ds_read_b64_tr_b16 v[232:233], v39 offset:16384
    ds_read_b64_tr_b16 v[234:235], v39 offset:16896
    v_mfma_f32_16x16x32_bf16 v[136:139], a[224:227], v[244:247], v[136:139]
    buffer_load_dwordx4 v11, s[56:59], s45 offen offset:2048 lds
    v_mfma_f32_16x16x32_bf16 v[108:111], a[228:231], v[240:243], v[108:111]
    ds_read_b64_tr_b16 v[236:237], v39 offset:18432
    ds_read_b64_tr_b16 v[238:239], v39 offset:18944
    v_mfma_f32_16x16x32_bf16 v[140:143], a[228:231], v[244:247], v[140:143]
    ds_read_b128 a[192:195], v32 offset:0
    ds_read_b128 a[196:199], v32 offset:2048
    v_mfma_f32_16x16x32_bf16 v[112:115], a[232:235], v[240:243], v[112:115]
    ds_read_b128 a[200:203], v32 offset:4096
    ds_read_b128 a[204:207], v32 offset:6144
    v_mfma_f32_16x16x32_bf16 v[144:147], a[232:235], v[244:247], v[144:147]
    buffer_load_dwordx4 v16, s[56:59], s45 offen offset:3072 lds
    v_mfma_f32_16x16x32_bf16 v[116:119], a[236:239], v[240:243], v[116:119]
    ds_read_b128 a[208:211], v32 offset:8192
    ds_read_b128 a[212:215], v32 offset:10240
    v_mfma_f32_16x16x32_bf16 v[148:151], a[236:239], v[244:247], v[148:151]
    ds_read_b128 a[216:219], v32 offset:12288
    s_addk_i32 m0, 0x4000
    v_mfma_f32_16x16x32_bf16 v[120:123], a[240:243], v[240:243], v[120:123]
    ds_read_b128 a[220:223], v32 offset:14336
    s_add_u32 s48, s48, s49
    v_mfma_f32_16x16x32_bf16 v[152:155], a[240:243], v[244:247], v[152:155]
    buffer_load_dwordx4 v17, s[60:63], s48 offen lds
    v_mfma_f32_16x16x32_bf16 v[124:127], a[244:247], v[240:243], v[124:127]
    ds_read_b128 a[80:83], v36 offset:0
    ds_read_u16_d16_hi v77, v49 offset:32
    v_mfma_f32_16x16x32_bf16 v[156:159], a[244:247], v[244:247], v[156:159]
    ds_read_b128 a[144:147], v46 offset:0
    ds_read_u16_d16_hi v78, v49 offset:64
    v_mfma_f32_16x16x32_bf16 v[128:131], a[248:251], v[240:243], v[128:131]
    ds_read_b128 a[224:227], v33 offset:0
    ds_read_u16_d16_hi v79, v49 offset:96
    v_mfma_f32_16x16x32_bf16 v[160:163], a[248:251], v[244:247], v[160:163]
    buffer_load_dwordx4 v18, s[60:63], s48 offen offset:1024 lds
    v_mfma_f32_16x16x32_bf16 v[132:135], a[252:255], v[240:243], v[132:135]
    ds_read_b128 a[228:231], v33 offset:2048
    s_add_u32 s43, s43, 0x9e3779b9
    v_mfma_f32_16x16x32_bf16 v[164:167], a[252:255], v[244:247], v[164:167]
    ds_read_b128 a[232:235], v33 offset:4096
    s_waitcnt lgkmcnt(12)
    v_mfma_f32_16x16x32_bf16 v[104:107], a[192:195], v[232:235], v[104:107]
    ds_read_b128 a[236:239], v33 offset:6144
    v_mov_b32 v101, s43
    v_mfma_f32_16x16x32_bf16 v[136:139], a[192:195], v[236:239], v[136:139]
    buffer_load_dwordx4 v17, s[64:67], s48 offen offset:2048 lds
    v_mfma_f32_16x16x32_bf16 v[108:111], a[196:199], v[232:235], v[108:111]
    ds_read_b128 a[240:243], v33 offset:8192
    v_mfma_f32_16x16x32_bf16 v[140:143], a[196:199], v[236:239], v[140:143]
    ds_read_b128 a[244:247], v33 offset:10240
    v_mfma_f32_16x16x32_bf16 v[112:115], a[200:203], v[232:235], v[112:115]
    ds_read_b128 a[248:251], v33 offset:12288
    v_mfma_f32_16x16x32_bf16 v[144:147], a[200:203], v[236:239], v[144:147]
    buffer_load_dwordx4 v18, s[64:67], s48 offen offset:3072 lds
    v_lshrrev_b32 v25, 5, v1
    v_mul_u32_u24 v4, 785408, v25
    v_add_u32 v5, v4, v24
    v_add_u32 v6, v4, v22
    v_mul_u32_u24 v4, 261632, v25
    v_add_u32 v4, v4, v10
    s_and_b32 s44, s76, 3
    s_cbranch_scc0 LX_pf_6
    buffer_load_dwordx4 v[12:15], v5, s[68:71], 0 offen
    buffer_load_dwordx4 v[12:15], v6, s[68:71], 0 offen offset:384
    buffer_load_dwordx4 v[12:15], v23, s[88:91], 0 offen
    buffer_load_dwordx4 v[12:15], v23, s[8:11], 0 offen offset:2048
    buffer_load_dwordx4 v[12:15], v4, s[4:7], s52 offen
LX_pf_6:
    v_mfma_f32_16x16x32_bf16 v[116:119], a[204:207], v[232:235], v[116:119]
    ds_read_b128 a[252:255], v33 offset:14336
    s_addk_i32 m0, 0x4000
    v_mfma_f32_16x16x32_bf16 v[148:151], a[204:207], v[236:239], v[148:151]
    ds_read_b64_tr_b16 v[240:241], v39 offset:24576
    s_waitcnt lgkmcnt(14)
    v_mfma_f32_16x16x32_bf16 v[120:123], a[208:211], v[232:235], v[120:123]
    ds_read_b64_tr_b16 v[242:243], v39 offset:25088
    ds_read_b64_tr_b16 v[244:245], v39 offset:26624
    v_mfma_f32_16x16x32_bf16 v[152:155], a[208:211], v[236:239], v[152:155]
    s_addk_i32 s45, 0x80
    buffer_load_dwordx4 v11, s[56:59], s45 offen lds
    v_mfma_f32_16x16x32_bf16 v[124:127], a[212:215], v[232:235], v[124:127]
    ds_read_b64_tr_b16 v[246:247], v39 offset:27136
    ds_read_b128 a[84:87], v37 offset:0
    v_mfma_f32_16x16x32_bf16 v[156:159], a[212:215], v[236:239], v[156:159]
    ds_read_b128 a[148:151], v47 offset:0
    v_mfma_f32_16x16x32_bf16 v[128:131], a[216:219], v[232:235], v[128:131]
    v_mfma_f32_16x16x32_bf16 v[160:163], a[216:219], v[236:239], v[160:163]
    buffer_load_dwordx4 v16, s[56:59], s45 offen offset:1024 lds
    v_mfma_f32_16x16x32_bf16 v[132:135], a[220:223], v[232:235], v[132:135]
    v_mfma_f32_16x16x32_bf16 v[164:167], a[220:223], v[236:239], v[164:167]
    s_waitcnt vmcnt(10) lgkmcnt(0)
    s_barrier
    v_mfma_f32_16x16x32_bf16 v[104:107], a[224:227], v[240:243], v[104:107]
    ds_read_b64_tr_b16 v[232:233], v39 offset:49152
    ds_read_b64_tr_b16 v[234:235], v39 offset:49664
    v_mfma_f32_16x16x32_bf16 v[136:139], a[224:227], v[244:247], v[136:139]
    buffer_load_dwordx4 v11, s[56:59], s45 offen offset:2048 lds
    v_mfma_f32_16x16x32_bf16 v[108:111], a[228:231], v[240:243], v[108:111]
    ds_read_b64_tr_b16 v[236:237], v39 offset:51200
    ds_read_b64_tr_b16 v[238:239], v39 offset:51712
    v_mfma_f32_16x16x32_bf16 v[140:143], a[228:231], v[244:247], v[140:143]
    ds_read_b128 a[192:195], v32 offset:32768
    ds_read_b128 a[196:199], v32 offset:34816
    v_mfma_f32_16x16x32_bf16 v[112:115], a[232:235], v[240:243], v[112:115]
    ds_read_b128 a[200:203], v32 offset:36864
    ds_read_b128 a[204:207], v32 offset:38912
    v_mfma_f32_16x16x32_bf16 v[144:147], a[232:235], v[244:247], v[144:147]
    buffer_load_dwordx4 v16, s[56:59], s45 offen offset:3072 lds
    v_mfma_f32_16x16x32_bf16 v[116:119], a[236:239], v[240:243], v[116:119]
    ds_read_b128 a[208:211], v32 offset:40960
    ds_read_b128 a[212:215], v32 offset:43008
    v_mfma_f32_16x16x32_bf16 v[148:151], a[236:239], v[244:247], v[148:151]
    ds_read_b128 a[216:219], v32 offset:45056
    s_addk_i32 m0, 0x4000
    v_mfma_f32_16x16x32_bf16 v[120:123], a[240:243], v[240:243], v[120:123]
    ds_read_b128 a[220:223], v32 offset:47104
    s_add_u32 s48, s48, s49
    v_mfma_f32_16x16x32_bf16 v[152:155], a[240:243], v[244:247], v[152:155]
    buffer_load_dwordx4 v17, s[60:63], s48 offen lds
    v_mfma_f32_16x16x32_bf16 v[124:127], a[244:247], v[240:243], v[124:127]
    ds_read_b128 a[88:91], v36 offset:32768
    v_mfma_f32_16x16x32_bf16 v[156:159], a[244:247], v[244:247], v[156:159]
    ds_read_b128 a[152:155], v46 offset:32768
    v_mfma_f32_16x16x32_bf16 v[128:131], a[248:251], v[240:243], v[128:131]
    ds_read_b128 a[224:227], v33 offset:32768
    v_mfma_f32_16x16x32_bf16 v[160:163], a[248:251], v[244:247], v[160:163]
    buffer_load_dwordx4 v18, s[60:63], s48 offen offset:1024 lds
    v_mfma_f32_16x16x32_bf16 v[132:135], a[252:255], v[240:243], v[132:135]
    ds_read_b128 a[228:231], v33 offset:34816
    v_mfma_f32_16x16x32_bf16 v[164:167], a[252:255], v[244:247], v[164:167]
    ds_read_b128 a[232:235], v33 offset:36864
    s_waitcnt lgkmcnt(9)
    v_mfma_f32_16x16x32_bf16 v[104:107], a[192:195], v[232:235], v[104:107]
    ds_read_b128 a[236:239], v33 offset:38912
    v_mfma_f32_16x16x32_bf16 v[136:139], a[192:195], v[236:239], v[136:139]
    buffer_load_dwordx4 v17, s[64:67], s48 offen offset:2048 lds
    v_mfma_f32_16x16x32_bf16 v[108:111], a[196:199], v[232:235], v[108:111]
    ds_read_b128 a[240:243], v33 offset:40960
    v_mfma_f32_16x16x32_bf16 v[140:143], a[196:199], v[236:239], v[140:143]
    ds_read_b128 a[244:247], v33 offset:43008
    v_mfma_f32_16x16x32_bf16 v[112:115], a[200:203], v[232:235], v[112:115]
    ds_read_b128 a[248:251], v33 offset:45056
    v_mfma_f32_16x16x32_bf16 v[144:147], a[200:203], v[236:239], v[144:147]
    buffer_load_dwordx4 v18, s[64:67], s48 offen offset:3072 lds
    s_and_b32 s44, s76, 12
    s_cbranch_scc0 LX_pf_7
    buffer_load_dwordx4 v[12:15], v5, s[68:71], 0 offen
    buffer_load_dwordx4 v[12:15], v6, s[68:71], 0 offen offset:384
    buffer_load_dwordx4 v[12:15], v23, s[88:91], 0 offen
    buffer_load_dwordx4 v[12:15], v23, s[8:11], 0 offen offset:2048
    buffer_load_dwordx4 v[12:15], v4, s[4:7], s52 offen
LX_pf_7:
    v_mfma_f32_16x16x32_bf16 v[116:119], a[204:207], v[232:235], v[116:119]
    ds_read_b128 a[252:255], v33 offset:47104
    s_addk_i32 m0, 0x4000
    v_mfma_f32_16x16x32_bf16 v[148:151], a[204:207], v[236:239], v[148:151]
    ds_read_b64_tr_b16 v[240:241], v39 offset:57344
    s_waitcnt lgkmcnt(11)
    v_mfma_f32_16x16x32_bf16 v[120:123], a[208:211], v[232:235], v[120:123]
    ds_read_b64_tr_b16 v[242:243], v39 offset:57856
    ds_read_b64_tr_b16 v[244:245], v39 offset:59392
    v_mfma_f32_16x16x32_bf16 v[152:155], a[208:211], v[236:239], v[152:155]
    s_addk_i32 s45, 0x80
    buffer_load_dwordx4 v11, s[56:59], s45 offen lds
    v_mfma_f32_16x16x32_bf16 v[124:127], a[212:215], v[232:235], v[124:127]
    ds_read_b64_tr_b16 v[246:247], v39 offset:59904
    ds_read_b128 a[92:95], v37 offset:32768
    v_mfma_f32_16x16x32_bf16 v[156:159], a[212:215], v[236:239], v[156:159]
    ds_read_b128 a[156:159], v47 offset:32768
    v_mfma_f32_16x16x32_bf16 v[128:131], a[216:219], v[232:235], v[128:131]
    v_mfma_f32_16x16x32_bf16 v[160:163], a[216:219], v[236:239], v[160:163]
    buffer_load_dwordx4 v16, s[56:59], s45 offen offset:1024 lds
    v_mfma_f32_16x16x32_bf16 v[132:135], a[220:223], v[232:235], v[132:135]
    v_mfma_f32_16x16x32_bf16 v[164:167], a[220:223], v[236:239], v[164:167]
    s_waitcnt vmcnt(10) lgkmcnt(0)
    s_barrier
    v_mfma_f32_16x16x32_bf16 v[104:107], a[224:227], v[240:243], v[104:107]
    ds_read_b64_tr_b16 v[232:233], v38 offset:16384
    ds_read_b64_tr_b16 v[234:235], v38 offset:16896
    v_mfma_f32_16x16x32_bf16 v[136:139], a[224:227], v[244:247], v[136:139]
    buffer_load_dwordx4 v11, s[56:59], s45 offen offset:2048 lds
    v_mfma_f32_16x16x32_bf16 v[108:111], a[228:231], v[240:243], v[108:111]
    ds_read_b64_tr_b16 v[236:237], v38 offset:18432
    ds_read_b64_tr_b16 v[238:239], v38 offset:18944
    v_mfma_f32_16x16x32_bf16 v[140:143], a[228:231], v[244:247], v[140:143]
    ds_read_b128 a[192:195], v30 offset:0
    ds_read_b128 a[196:199], v30 offset:2048
    v_mfma_f32_16x16x32_bf16 v[112:115], a[232:235], v[240:243], v[112:115]
    ds_read_b128 a[200:203], v30 offset:4096
    ds_read_b128 a[204:207], v30 offset:6144
    v_mfma_f32_16x16x32_bf16 v[144:147], a[232:235], v[244:247], v[144:147]
    buffer_load_dwordx4 v16, s[56:59], s45 offen offset:3072 lds
    v_mfma_f32_16x16x32_bf16 v[116:119], a[236:239], v[240:243], v[116:119]
    ds_read_b128 a[208:211], v30 offset:8192
    ds_read_b128 a[212:215], v30 offset:10240
    v_mfma_f32_16x16x32_bf16 v[148:151], a[236:239], v[244:247], v[148:151]
    ds_read_b128 a[216:219], v30 offset:12288
    s_addk_i32 m0, 0x4000
    v_mfma_f32_16x16x32_bf16 v[120:123], a[240:243], v[240:243], v[120:123]
    ds_read_b128 a[220:223], v30 offset:14336
    s_add_u32 s48, s48, s49
    v_mfma_f32_16x16x32_bf16 v[152:155], a[240:243], v[244:247], v[152:155]
    buffer_load_dwordx4 v17, s[60:63], s48 offen lds
    v_mfma_f32_16x16x32_bf16 v[124:127], a[244:247], v[240:243], v[124:127]
    ds_read_b128 a[96:99], v34 offset:0
    ds_read_u16_d16_hi v60, v51 offset:0
    v_mfma_f32_16x16x32_bf16 v[156:159], a[244:247], v[244:247], v[156:159]
    ds_read_b128 a[160:163], v44 offset:0
    ds_read_u16_d16_hi v61, v51 offset:128
    v_mfma_f32_16x16x32_bf16 v[128:131], a[248:251], v[240:243], v[128:131]
    ds_read_b128 a[224:227], v31 offset:0
    ds_read_u16_d16_hi v62, v52 offset:256
    v_mfma_f32_16x16x32_bf16 v[160:163], a[248:251], v[244:247], v[160:163]
    buffer_load_dwordx4 v18, s[60:63], s48 offen offset:1024 lds
    v_mfma_f32_16x16x32_bf16 v[132:135], a[252:255], v[240:243], v[132:135]
    ds_read_b128 a[228:231], v31 offset:2048
    ds_read_u16_d16_hi v63, v52 offset:384
    v_mfma_f32_16x16x32_bf16 v[164:167], a[252:255], v[244:247], v[164:167]
    ds_read_b128 a[232:235], v31 offset:4096
    s_waitcnt lgkmcnt(13)
    v_mfma_f32_16x16x32_bf16 v[104:107], a[192:195], v[232:235], v[104:107]
    ds_read_b128 a[236:239], v31 offset:6144
    ds_read_u16_d16_hi v64, v53 offset:0
    v_mfma_f32_16x16x32_bf16 v[136:139], a[192:195], v[236:239], v[136:139]
    buffer_load_dwordx4 v17, s[64:67], s48 offen offset:2048 lds
    v_mfma_f32_16x16x32_bf16 v[108:111], a[196:199], v[232:235], v[108:111]
    ds_read_b128 a[240:243], v31 offset:8192
    ds_read_u16_d16_hi v65, v53 offset:128
    v_mfma_f32_16x16x32_bf16 v[140:143], a[196:199], v[236:239], v[140:143]
    ds_read_b128 a[244:247], v31 offset:10240
    ds_read_u16_d16_hi v66, v54 offset:256
    v_mfma_f32_16x16x32_bf16 v[112:115], a[200:203], v[232:235], v[112:115]
    ds_read_b128 a[248:251], v31 offset:12288
    ds_read_u16_d16_hi v67, v54 offset:384
    v_mfma_f32_16x16x32_bf16 v[144:147], a[200:203], v[236:239], v[144:147]
    buffer_load_dwordx4 v18, s[64:67], s48 offen offset:3072 lds
    v_mfma_f32_16x16x32_bf16 v[116:119], a[204:207], v[232:235], v[116:119]
    ds_read_b128 a[252:255], v31 offset:14336
    s_addk_i32 m0, 0x4000
    v_mfma_f32_16x16x32_bf16 v[148:151], a[204:207], v[236:239], v[148:151]
    ds_read_b64_tr_b16 v[240:241], v38 offset:24576
    s_waitcnt lgkmcnt(15)
    v_mfma_f32_16x16x32_bf16 v[120:123], a[208:211], v[232:235], v[120:123]
    ds_read_b64_tr_b16 v[242:243], v38 offset:25088
    ds_read_b64_tr_b16 v[244:245], v38 offset:26624
    v_mfma_f32_16x16x32_bf16 v[152:155], a[208:211], v[236:239], v[152:155]
    s_addk_i32 s45, 0x80
    buffer_load_dwordx4 v11, s[56:59], s45 offen lds
    v_mfma_f32_16x16x32_bf16 v[124:127], a[212:215], v[232:235], v[124:127]
    ds_read_b64_tr_b16 v[246:247], v38 offset:27136
    ds_read_b128 a[100:103], v35 offset:0
    v_mfma_f32_16x16x32_bf16 v[156:159], a[212:215], v[236:239], v[156:159]
    ds_read_b128 a[164:167], v45 offset:0
    ds_read_u16_d16_hi v68, v55 offset:0
    v_mfma_f32_16x16x32_bf16 v[128:131], a[216:219], v[232:235], v[128:131]
    v_mfma_f32_16x16x32_bf16 v[160:163], a[216:219], v[236:239], v[160:163]
    buffer_load_dwordx4 v16, s[56:59], s45 offen offset:1024 lds
    v_mfma_f32_16x16x32_bf16 v[132:135], a[220:223], v[232:235], v[132:135]
    v_mfma_f32_16x16x32_bf16 v[164:167], a[220:223], v[236:239], v[164:167]
    s_waitcnt vmcnt(10) lgkmcnt(0)
    s_barrier
    v_mfma_f32_16x16x32_bf16 v[104:107], a[224:227], v[240:243], v[104:107]
    ds_read_b64_tr_b16 v[232:233], v38 offset:49152
    ds_read_b64_tr_b16 v[234:235], v38 offset:49664
    v_mfma_f32_16x16x32_bf16 v[136:139], a[224:227], v[244:247], v[136:139]
    buffer_load_dwordx4 v11, s[56:59], s45 offen offset:2048 lds
    v_mfma_f32_16x16x32_bf16 v[108:111], a[228:231], v[240:243], v[108:111]
    ds_read_b64_tr_b16 v[236:237], v38 offset:51200
    ds_read_b64_tr_b16 v[238:239], v38 offset:51712
    v_mfma_f32_16x16x32_bf16 v[140:143], a[228:231], v[244:247], v[140:143]
    ds_read_b128 a[192:195], v30 offset:32768
    ds_read_b128 a[196:199], v30 offset:34816
    v_mfma_f32_16x16x32_bf16 v[112:115], a[232:235], v[240:243], v[112:115]
    ds_read_b128 a[200:203], v30 offset:36864
    ds_read_b128 a[204:207], v30 offset:38912
    v_mfma_f32_16x16x32_bf16 v[144:147], a[232:235], v[244:247], v[144:147]
    buffer_load_dwordx4 v16, s[56:59], s45 offen offset:3072 lds
    v_mfma_f32_16x16x32_bf16 v[116:119], a[236:239], v[240:243], v[116:119]
    ds_read_b128 a[208:211], v30 offset:40960
    ds_read_b128 a[212:215], v30 offset:43008
    v_mfma_f32_16x16x32_bf16 v[148:151], a[236:239], v[244:247], v[148:151]
    ds_read_b128 a[216:219], v30 offset:45056
    s_addk_i32 m0, 0x4000
    v_mfma_f32_16x16x32_bf16 v[120:123], a[240:243], v[240:243], v[120:123]
    ds_read_b128 a[220:223], v30 offset:47104
    s_add_u32 s48, s48, s49
    v_mfma_f32_16x16x32_bf16 v[152:155], a[240:243], v[244:247], v[152:155]
    buffer_load_dwordx4 v17, s[60:63], s48 offen lds
    v_mfma_f32_16x16x32_bf16 v[124:127], a[244:247], v[240:243], v[124:127]
    ds_read_b128 a[104:107], v34 offset:32768
    ds_read_u16_d16_hi v69, v55 offset:128
    v_mfma_f32_16x16x32_bf16 v[156:159], a[244:247], v[244:247], v[156:159]
    ds_read_b128 a[168:171], v44 offset:32768
    ds_read_u16_d16_hi v70, v56 offset:256
    v_mfma_f32_16x16x32_bf16 v[128:131], a[248:251], v[240:243], v[128:131]
    ds_read_b128 a[224:227], v31 offset:32768
    ds_read_u16_d16_hi v71, v56 offset:384
    v_mfma_f32_16x16x32_bf16 v[160:163], a[248:251], v[244:247], v[160:163]
    buffer_load_dwordx4 v18, s[60:63], s48 offen offset:1024 lds
    v_mfma_f32_16x16x32_bf16 v[132:135], a[252:255], v[240:243], v[132:135]
    ds_read_b128 a[228:231], v31 offset:34816
    ds_read_u16_d16_hi v72, v57 offset:0
    v_mfma_f32_16x16x32_bf16 v[164:167], a[252:255], v[244:247], v[164:167]
    ds_read_b128 a[232:235], v31 offset:36864
    s_waitcnt lgkmcnt(13)
    v_mfma_f32_16x16x32_bf16 v[104:107], a[192:195], v[232:235], v[104:107]
    ds_read_b128 a[236:239], v31 offset:38912
    ds_read_u16_d16_hi v73, v57 offset:128
    v_mfma_f32_16x16x32_bf16 v[136:139], a[192:195], v[236:239], v[136:139]
    buffer_load_dwordx4 v17, s[64:67], s48 offen offset:2048 lds
    v_mfma_f32_16x16x32_bf16 v[108:111], a[196:199], v[232:235], v[108:111]
    ds_read_b128 a[240:243], v31 offset:40960
    ds_read_u16_d16_hi v74, v58 offset:256
    v_mfma_f32_16x16x32_bf16 v[140:143], a[196:199], v[236:239], v[140:143]
    ds_read_b128 a[244:247], v31 offset:43008
    ds_read_u16_d16_hi v75, v58 offset:384
    v_mfma_f32_16x16x32_bf16 v[112:115], a[200:203], v[232:235], v[112:115]
    ds_read_b128 a[248:251], v31 offset:45056
    v_mfma_f32_16x16x32_bf16 v[144:147], a[200:203], v[236:239], v[144:147]
    buffer_load_dwordx4 v18, s[64:67], s48 offen offset:3072 lds
    v_mfma_f32_16x16x32_bf16 v[116:119], a[204:207], v[232:235], v[116:119]
    ds_read_b128 a[252:255], v31 offset:47104
    s_add_u32 m0, s47, 0x0
    v_mfma_f32_16x16x32_bf16 v[148:151], a[204:207], v[236:239], v[148:151]
    ds_read_b64_tr_b16 v[240:241], v38 offset:57344
    s_waitcnt lgkmcnt(15)
    v_mfma_f32_16x16x32_bf16 v[120:123], a[208:211], v[232:235], v[120:123]
    ds_read_b64_tr_b16 v[242:243], v38 offset:57856
    ds_read_b64_tr_b16 v[244:245], v38 offset:59392
    v_mfma_f32_16x16x32_bf16 v[152:155], a[208:211], v[236:239], v[152:155]
    s_add_u32 s53, s50, 0x0
    buffer_load_dwordx4 v17, s[68:71], s53 offen lds
    v_mfma_f32_16x16x32_bf16 v[124:127], a[212:215], v[232:235], v[124:127]
    ds_read_b64_tr_b16 v[246:247], v38 offset:59904
    ds_read_b128 a[108:111], v35 offset:32768
    v_mfma_f32_16x16x32_bf16 v[156:159], a[212:215], v[236:239], v[156:159]
    ds_read_b128 a[172:175], v45 offset:32768
    v_mfma_f32_16x16x32_bf16 v[128:131], a[216:219], v[232:235], v[128:131]
    v_mfma_f32_16x16x32_bf16 v[160:163], a[216:219], v[236:239], v[160:163]
    buffer_load_dwordx4 v18, s[68:71], s53 offen offset:1024 lds
    v_mfma_f32_16x16x32_bf16 v[132:135], a[220:223], v[232:235], v[132:135]
    s_add_u32 s53, s50, 0xb800
    v_mfma_f32_16x16x32_bf16 v[164:167], a[220:223], v[236:239], v[164:167]
    s_waitcnt vmcnt(10) lgkmcnt(0)
    s_barrier
    v_mfma_f32_16x16x32_bf16 v[104:107], a[224:227], v[240:243], v[104:107]
    ds_read_b64_tr_b16 v[232:233], v39 offset:16384
    ds_read_b64_tr_b16 v[234:235], v39 offset:16896
    v_mfma_f32_16x16x32_bf16 v[136:139], a[224:227], v[244:247], v[136:139]
    buffer_load_dwordx4 v17, s[68:71], s53 offen offset:2048 lds
    v_mfma_f32_16x16x32_bf16 v[108:111], a[228:231], v[240:243], v[108:111]
    ds_read_b64_tr_b16 v[236:237], v39 offset:18432
    ds_read_b64_tr_b16 v[238:239], v39 offset:18944
    v_mfma_f32_16x16x32_bf16 v[140:143], a[228:231], v[244:247], v[140:143]
    ds_read_b128 a[192:195], v32 offset:0
    ds_read_b128 a[196:199], v32 offset:2048
    v_mfma_f32_16x16x32_bf16 v[112:115], a[232:235], v[240:243], v[112:115]
    ds_read_b128 a[200:203], v32 offset:4096
    ds_read_b128 a[204:207], v32 offset:6144
    v_mfma_f32_16x16x32_bf16 v[144:147], a[232:235], v[244:247], v[144:147]
    buffer_load_dwordx4 v18, s[68:71], s53 offen offset:3072 lds
    v_mfma_f32_16x16x32_bf16 v[116:119], a[236:239], v[240:243], v[116:119]
    ds_read_b128 a[208:211], v32 offset:8192
    ds_read_b128 a[212:215], v32 offset:10240
    v_mfma_f32_16x16x32_bf16 v[148:151], a[236:239], v[244:247], v[148:151]
    ds_read_b128 a[216:219], v32 offset:12288
    s_add_u32 m0, s47, 0x4000
    v_mfma_f32_16x16x32_bf16 v[120:123], a[240:243], v[240:243], v[120:123]
    ds_read_b128 a[220:223], v32 offset:14336
    s_add_u32 s53, s50, 0x60000
    v_mfma_f32_16x16x32_bf16 v[152:155], a[240:243], v[244:247], v[152:155]
    buffer_load_dwordx4 v17, s[68:71], s53 offen lds
    v_mfma_f32_16x16x32_bf16 v[124:127], a[244:247], v[240:243], v[124:127]
    ds_read_b128 a[112:115], v36 offset:0
    v_mfma_f32_16x16x32_bf16 v[156:159], a[244:247], v[244:247], v[156:159]
    ds_read_b128 a[176:179], v46 offset:0
    v_mfma_f32_16x16x32_bf16 v[128:131], a[248:251], v[240:243], v[128:131]
    ds_read_b128 a[224:227], v33 offset:0
    v_mfma_f32_16x16x32_bf16 v[160:163], a[248:251], v[244:247], v[160:163]
    buffer_load_dwordx4 v18, s[68:71], s53 offen offset:1024 lds
    v_mfma_f32_16x16x32_bf16 v[132:135], a[252:255], v[240:243], v[132:135]
    ds_read_b128 a[228:231], v33 offset:2048
    s_add_u32 s53, s50, 0x6b800
    v_mfma_f32_16x16x32_bf16 v[164:167], a[252:255], v[244:247], v[164:167]
    ds_read_b128 a[232:235], v33 offset:4096
    s_waitcnt lgkmcnt(9)
    v_mfma_f32_16x16x32_bf16 v[104:107], a[192:195], v[232:235], v[104:107]
    ds_read_b128 a[236:239], v33 offset:6144
    v_mfma_f32_16x16x32_bf16 v[136:139], a[192:195], v[236:239], v[136:139]
    buffer_load_dwordx4 v17, s[68:71], s53 offen offset:2048 lds
    v_mfma_f32_16x16x32_bf16 v[108:111], a[196:199], v[232:235], v[108:111]
    ds_read_b128 a[240:243], v33 offset:8192
    v_mfma_f32_16x16x32_bf16 v[140:143], a[196:199], v[236:239], v[140:143]
    ds_read_b128 a[244:247], v33 offset:10240
    v_mfma_f32_16x16x32_bf16 v[112:115], a[200:203], v[232:235], v[112:115]
    ds_read_b128 a[248:251], v33 offset:12288
    v_mfma_f32_16x16x32_bf16 v[144:147], a[200:203], v[236:239], v[144:147]
    buffer_load_dwordx4 v18, s[68:71], s53 offen offset:3072 lds
    v_mfma_f32_16x16x32_bf16 v[116:119], a[204:207], v[232:235], v[116:119]
    ds_read_b128 a[252:255], v33 offset:14336
    s_add_u32 m0, s47, 0x8000
    v_mfma_f32_16x16x32_bf16 v[148:151], a[204:207], v[236:239], v[148:151]
    ds_read_b64_tr_b16 v[240:241], v39 offset:24576
    s_waitcnt lgkmcnt(11)
    v_mfma_f32_16x16x32_bf16 v[120:123], a[208:211], v[232:235], v[120:123]
    ds_read_b64_tr_b16 v[242:243], v39 offset:25088
    ds_read_b64_tr_b16 v[244:245], v39 offset:26624
    v_mfma_f32_16x16x32_bf16 v[152:155], a[208:211], v[236:239], v[152:155]
    s_add_u32 s53, s50, 0xc0000
    buffer_load_dwordx4 v17, s[68:71], s53 offen lds
    v_mfma_f32_16x16x32_bf16 v[124:127], a[212:215], v[232:235], v[124:127]
    ds_read_b64_tr_b16 v[246:247], v39 offset:27136
    ds_read_b128 a[116:119], v37 offset:0
    v_mfma_f32_16x16x32_bf16 v[156:159], a[212:215], v[236:239], v[156:159]
    ds_read_b128 a[180:183], v47 offset:0
    v_mfma_f32_16x16x32_bf16 v[128:131], a[216:219], v[232:235], v[128:131]
    v_mfma_f32_16x16x32_bf16 v[160:163], a[216:219], v[236:239], v[160:163]
    buffer_load_dwordx4 v18, s[68:71], s53 offen offset:1024 lds
    v_mfma_f32_16x16x32_bf16 v[132:135], a[220:223], v[232:235], v[132:135]
    s_add_u32 s53, s50, 0xcb800
    v_mfma_f32_16x16x32_bf16 v[164:167], a[220:223], v[236:239], v[164:167]
    s_waitcnt vmcnt(10) lgkmcnt(0)
    s_barrier
    v_mfma_f32_16x16x32_bf16 v[104:107], a[224:227], v[240:243], v[104:107]
    ds_read_b64_tr_b16 v[232:233], v39 offset:49152
    ds_read_b64_tr_b16 v[234:235], v39 offset:49664
    v_mfma_f32_16x16x32_bf16 v[136:139], a[224:227], v[244:247], v[136:139]
    buffer_load_dwordx4 v17, s[68:71], s53 offen offset:2048 lds
    v_mfma_f32_16x16x32_bf16 v[108:111], a[228:231], v[240:243], v[108:111]
    ds_read_b64_tr_b16 v[236:237], v39 offset:51200
    ds_read_b64_tr_b16 v[238:239], v39 offset:51712
    v_mfma_f32_16x16x32_bf16 v[140:143], a[228:231], v[244:247], v[140:143]
    ds_read_b128 a[192:195], v32 offset:32768
    ds_read_b128 a[196:199], v32 offset:34816
    v_mfma_f32_16x16x32_bf16 v[112:115], a[232:235], v[240:243], v[112:115]
    ds_read_b128 a[200:203], v32 offset:36864
    ds_read_b128 a[204:207], v32 offset:38912
    v_mfma_f32_16x16x32_bf16 v[144:147], a[232:235], v[244:247], v[144:147]
    buffer_load_dwordx4 v18, s[68:71], s53 offen offset:3072 lds
    v_mfma_f32_16x16x32_bf16 v[116:119], a[236:239], v[240:243], v[116:119]
    ds_read_b128 a[208:211], v32 offset:40960
    ds_read_b128 a[212:215], v32 offset:43008
    v_mfma_f32_16x16x32_bf16 v[148:151], a[236:239], v[244:247], v[148:151]
    ds_read_b128 a[216:219], v32 offset:45056
    s_add_u32 m0, s47, 0xc000
    v_mfma_f32_16x16x32_bf16 v[120:123], a[240:243], v[240:243], v[120:123]
    ds_read_b128 a[220:223], v32 offset:47104
    s_add_u32 s53, s50, 0x120000
    v_mfma_f32_16x16x32_bf16 v[152:155], a[240:243], v[244:247], v[152:155]
    buffer_load_dwordx4 v17, s[68:71], s53 offen lds
    v_mfma_f32_16x16x32_bf16 v[124:127], a[244:247], v[240:243], v[124:127]
    ds_read_b128 a[120:123], v36 offset:32768
    v_mfma_f32_16x16x32_bf16 v[156:159], a[244:247], v[244:247], v[156:159]
    ds_read_b128 a[184:187], v46 offset:32768
    v_mfma_f32_16x16x32_bf16 v[128:131], a[248:251], v[240:243], v[128:131]
    ds_read_b128 a[224:227], v33 offset:32768
    v_mfma_f32_16x16x32_bf16 v[160:163], a[248:251], v[244:247], v[160:163]
    buffer_load_dwordx4 v18, s[68:71], s53 offen offset:1024 lds
    v_mfma_f32_16x16x32_bf16 v[132:135], a[252:255], v[240:243], v[132:135]
    ds_read_b128 a[228:231], v33 offset:34816
    s_add_u32 s53, s50, 0x12b800
    v_mfma_f32_16x16x32_bf16 v[164:167], a[252:255], v[244:247], v[164:167]
    ds_read_b128 a[232:235], v33 offset:36864
    s_waitcnt lgkmcnt(9)
    v_mfma_f32_16x16x32_bf16 v[104:107], a[192:195], v[232:235], v[104:107]
    ds_read_b128 a[236:239], v33 offset:38912
    v_mfma_f32_16x16x32_bf16 v[136:139], a[192:195], v[236:239], v[136:139]
    buffer_load_dwordx4 v17, s[68:71], s53 offen offset:2048 lds
    v_mfma_f32_16x16x32_bf16 v[108:111], a[196:199], v[232:235], v[108:111]
    ds_read_b128 a[240:243], v33 offset:40960
    v_mfma_f32_16x16x32_bf16 v[140:143], a[196:199], v[236:239], v[140:143]
    ds_read_b128 a[244:247], v33 offset:43008
    v_mfma_f32_16x16x32_bf16 v[112:115], a[200:203], v[232:235], v[112:115]
    ds_read_b128 a[248:251], v33 offset:45056
    v_mfma_f32_16x16x32_bf16 v[144:147], a[200:203], v[236:239], v[144:147]
    buffer_load_dwordx4 v18, s[68:71], s53 offen offset:3072 lds
    v_mfma_f32_16x16x32_bf16 v[116:119], a[204:207], v[232:235], v[116:119]
    ds_read_b128 a[252:255], v33 offset:47104
    s_add_u32 m0, s47, 0x20000
    v_mfma_f32_16x16x32_bf16 v[148:151], a[204:207], v[236:239], v[148:151]
    ds_read_b64_tr_b16 v[240:241], v39 offset:57344
    s_waitcnt lgkmcnt(11)
    v_mfma_f32_16x16x32_bf16 v[120:123], a[208:211], v[232:235], v[120:123]
    ds_read_b64_tr_b16 v[242:243], v39 offset:57856
    ds_read_b64_tr_b16 v[244:245], v39 offset:59392
    v_mfma_f32_16x16x32_bf16 v[152:155], a[208:211], v[236:239], v[152:155]
    s_add_u32 s53, s22, 0x0
    buffer_load_dwordx4 v19, s[88:91], s53 offen lds
    v_mfma_f32_16x16x32_bf16 v[124:127], a[212:215], v[232:235], v[124:127]
    ds_read_b64_tr_b16 v[246:247], v39 offset:59904
    ds_read_b128 a[124:127], v37 offset:32768
    v_mfma_f32_16x16x32_bf16 v[156:159], a[212:215], v[236:239], v[156:159]
    ds_read_b128 a[188:191], v47 offset:32768
    v_mfma_f32_16x16x32_bf16 v[128:131], a[216:219], v[232:235], v[128:131]
    v_mfma_f32_16x16x32_bf16 v[160:163], a[216:219], v[236:239], v[160:163]
    buffer_load_dwordx4 v20, s[88:91], s53 offen offset:1024 lds
    v_mfma_f32_16x16x32_bf16 v[132:135], a[220:223], v[232:235], v[132:135]
    v_mfma_f32_16x16x32_bf16 v[164:167], a[220:223], v[236:239], v[164:167]
    s_waitcnt lgkmcnt(0)
    s_barrier
    v_mfma_f32_16x16x32_bf16 v[104:107], a[224:227], v[240:243], v[104:107]
    v_mfma_f32_16x16x32_bf16 v[108:111], a[228:231], v[240:243], v[108:111]
    buffer_load_dwordx4 v19, s[8:11], s53 offen offset:2048 lds
    v_mfma_f32_16x16x32_bf16 v[112:115], a[232:235], v[240:243], v[112:115]
    v_mfma_f32_16x16x32_bf16 v[116:119], a[236:239], v[240:243], v[116:119]
    v_mfma_f32_16x16x32_bf16 v[120:123], a[240:243], v[240:243], v[120:123]
    s_nop 2
    v_fma_f32 v184, v104, v172, -v172
    v_fma_f32 v185, v105, v172, -v172
    v_mfma_f32_16x16x32_bf16 v[124:127], a[244:247], v[240:243], v[124:127]
    buffer_load_dwordx4 v20, s[8:11], s53 offen offset:3072 lds
    v_mfma_f32_16x16x32_bf16 v[128:131], a[248:251], v[240:243], v[128:131]
    v_fma_f32 v186, v106, v172, -v172
    v_fma_f32 v187, v107, v172, -v172
    s_add_u32 m0, s47, 0x24000
    v_mfma_f32_16x16x32_bf16 v[132:135], a[252:255], v[240:243], v[132:135]
    v_exp_f32_e64 v184, v184 clamp
    s_add_u32 s53, s22, 0x80
    v_mfma_f32_16x16x32_bf16 v[136:139], a[224:227], v[244:247], v[136:139]
    v_exp_f32_e64 v185, v185 clamp
    v_mfma_f32_16x16x32_bf16 v[140:143], a[228:231], v[244:247], v[140:143]
    buffer_load_dwordx4 v19, s[88:91], s53 offen lds
    v_mfma_f32_16x16x32_bf16 v[144:147], a[232:235], v[244:247], v[144:147]
    v_exp_f32_e64 v186, v186 clamp
    v_mfma_f32_16x16x32_bf16 v[148:151], a[236:239], v[244:247], v[148:151]
    v_exp_f32_e64 v187, v187 clamp
    v_mfma_f32_16x16x32_bf16 v[152:155], a[240:243], v[244:247], v[152:155]
    v_max_f32 v184, v184, v104
    v_max_f32 v185, v185, v105
    v_mfma_f32_16x16x32_bf16 v[156:159], a[244:247], v[244:247], v[156:159]
    buffer_load_dwordx4 v20, s[88:91], s53 offen offset:1024 lds
    v_mfma_f32_16x16x32_bf16 v[160:163], a[248:251], v[244:247], v[160:163]
    v_max_f32 v186, v186, v106
    v_max_f32 v187, v187, v107
    v_mfma_f32_16x16x32_bf16 v[164:167], a[252:255], v[244:247], v[164:167]
    v_add_f32_e64 v184, v184, v173
    v_add_f32_e64 v185, v185, v173
    buffer_load_dwordx4 v19, s[8:11], s53 offen offset:2048 lds
    v_pk_add_f32 v[186:187], v[186:187], v[172:173] op_sel:[0,1]
    v_cvt_pk_bf16_f32 v188, v184, v185
    v_cvt_pk_bf16_f32 v189, v186, v187
    v_pk_fma_f32 v[184:185], v[108:109], v[172:173], v[172:173] op_sel_hi:[1,0,0] neg_lo:[0,0,1] neg_hi:[0,0,1]
    v_pk_fma_f32 v[186:187], v[110:111], v[172:173], v[172:173] op_sel_hi:[1,0,0] neg_lo:[0,0,1] neg_hi:[0,0,1]
    v_exp_f32_e64 v184, v184 clamp
    v_exp_f32_e64 v185, v185 clamp
    v_exp_f32_e64 v186, v186 clamp
    v_exp_f32_e64 v187, v187 clamp
    v_max_f32 v184, v184, v108
    v_max_f32 v185, v185, v109
    v_max_f32 v186, v186, v110
    v_max_f32 v187, v187, v111
    v_pk_add_f32 v[184:185], v[184:185], v[172:173] op_sel:[0,1]
    buffer_load_dwordx4 v20, s[8:11], s53 offen offset:3072 lds
    v_pk_add_f32 v[186:187], v[186:187], v[172:173] op_sel:[0,1]
    v_cvt_pk_bf16_f32 v190, v184, v185
    v_cvt_pk_bf16_f32 v191, v186, v187
    v_pk_fma_f32 v[184:185], v[112:113], v[172:173], v[172:173] op_sel_hi:[1,0,0] neg_lo:[0,0,1] neg_hi:[0,0,1]
    v_pk_fma_f32 v[186:187], v[114:115], v[172:173], v[172:173] op_sel_hi:[1,0,0] neg_lo:[0,0,1] neg_hi:[0,0,1]
    v_mfma_f32_16x16x32_bf16 v[228:231], v[188:191], v[176:179], 0
    v_cvt_pk_bf16_f32 v204, v136, v137
    v_cvt_pk_bf16_f32 v205, v138, v139
    v_cvt_pk_bf16_f32 v206, v140, v141
    v_cvt_pk_bf16_f32 v207, v142, v143
    v_exp_f32_e64 v184, v184 clamp
    v_exp_f32_e64 v185, v185 clamp
    v_exp_f32_e64 v186, v186 clamp
    v_exp_f32_e64 v187, v187 clamp
    s_add_u32 m0, s47, 0x10000
    s_add_u32 s53, s22, 0x100
    buffer_load_dwordx4 v19, s[88:91], s53 offen lds
    v_max_f32 v184, v184, v112
    v_max_f32 v185, v185, v113
    v_max_f32 v186, v186, v114
    v_max_f32 v187, v187, v115
    v_pk_add_f32 v[184:185], v[184:185], v[172:173] op_sel:[0,1]
    v_pk_add_f32 v[186:187], v[186:187], v[172:173] op_sel:[0,1]
    v_cvt_pk_bf16_f32 v192, v184, v185
    v_cvt_pk_bf16_f32 v193, v186, v187
    v_pk_fma_f32 v[184:185], v[116:117], v[172:173], v[172:173] op_sel_hi:[1,0,0] neg_lo:[0,0,1] neg_hi:[0,0,1]
    v_pk_fma_f32 v[186:187], v[118:119], v[172:173], v[172:173] op_sel_hi:[1,0,0] neg_lo:[0,0,1] neg_hi:[0,0,1]
    v_mfma_f32_16x16x32_bf16 v[220:223], v[188:191], v[204:207], 0
    v_exp_f32_e64 v184, v184 clamp
    v_exp_f32_e64 v185, v185 clamp
    v_exp_f32_e64 v186, v186 clamp
    buffer_load_dwordx4 v20, s[88:91], s53 offen offset:1024 lds
    v_exp_f32_e64 v187, v187 clamp
    v_max_f32 v184, v184, v116
    v_max_f32 v185, v185, v117
    v_max_f32 v186, v186, v118
    v_max_f32 v187, v187, v119
    v_pk_add_f32 v[184:185], v[184:185], v[172:173] op_sel:[0,1]
    v_pk_add_f32 v[186:187], v[186:187], v[172:173] op_sel:[0,1]
    v_cvt_pk_bf16_f32 v194, v184, v185
    v_cvt_pk_bf16_f32 v195, v186, v187
    v_pk_fma_f32 v[184:185], v[120:121], v[172:173], v[172:173] op_sel_hi:[1,0,0] neg_lo:[0,0,1] neg_hi:[0,0,1]
    v_pk_fma_f32 v[186:187], v[122:123], v[172:173], v[172:173] op_sel_hi:[1,0,0] neg_lo:[0,0,1] neg_hi:[0,0,1]
    v_mfma_f32_16x16x32_bf16 v[228:231], v[192:195], v[176:179], v[228:231]
    v_cvt_pk_bf16_f32 v208, v144, v145
    v_cvt_pk_bf16_f32 v209, v146, v147
    buffer_load_dwordx4 v19, s[8:11], s53 offen offset:2048 lds
    v_cvt_pk_bf16_f32 v210, v148, v149
    v_cvt_pk_bf16_f32 v211, v150, v151
    v_exp_f32_e64 v184, v184 clamp
    v_exp_f32_e64 v185, v185 clamp
    v_exp_f32_e64 v186, v186 clamp
    v_exp_f32_e64 v187, v187 clamp
    v_max_f32 v184, v184, v120
    v_max_f32 v185, v185, v121
    v_max_f32 v186, v186, v122
    v_max_f32 v187, v187, v123
    v_pk_add_f32 v[184:185], v[184:185], v[172:173] op_sel:[0,1]
    v_pk_add_f32 v[186:187], v[186:187], v[172:173] op_sel:[0,1]
    v_cvt_pk_bf16_f32 v196, v184, v185
    v_cvt_pk_bf16_f32 v197, v186, v187
    buffer_load_dwordx4 v20, s[8:11], s53 offen offset:3072 lds
    v_pk_fma_f32 v[184:185], v[124:125], v[172:173], v[172:173] op_sel_hi:[1,0,0] neg_lo:[0,0,1] neg_hi:[0,0,1]
    v_pk_fma_f32 v[186:187], v[126:127], v[172:173], v[172:173] op_sel_hi:[1,0,0] neg_lo:[0,0,1] neg_hi:[0,0,1]
    v_mfma_f32_16x16x32_bf16 v[220:223], v[192:195], v[208:211], v[220:223]
    v_exp_f32_e64 v184, v184 clamp
    v_exp_f32_e64 v185, v185 clamp
    v_exp_f32_e64 v186, v186 clamp
    v_exp_f32_e64 v187, v187 clamp
    v_max_f32 v184, v184, v124
    v_max_f32 v185, v185, v125
    v_max_f32 v186, v186, v126
    v_max_f32 v187, v187, v127
    v_pk_add_f32 v[184:185], v[184:185], v[172:173] op_sel:[0,1]
    v_pk_add_f32 v[186:187], v[186:187], v[172:173] op_sel:[0,1]
    v_cvt_pk_bf16_f32 v198, v184, v185
    s_add_u32 m0, s47, 0x14000
    s_add_u32 s53, s22, 0x180
    buffer_load_dwordx4 v19, s[88:91], s53 offen lds
    v_cvt_pk_bf16_f32 v199, v186, v187
    v_pk_fma_f32 v[184:185], v[128:129], v[172:173], v[172:173] op_sel_hi:[1,0,0] neg_lo:[0,0,1] neg_hi:[0,0,1]
    v_pk_fma_f32 v[186:187], v[130:131], v[172:173], v[172:173] op_sel_hi:[1,0,0] neg_lo:[0,0,1] neg_hi:[0,0,1]
    v_mfma_f32_16x16x32_bf16 v[228:231], v[196:199], v[176:179], v[228:231]
    v_cvt_pk_bf16_f32 v212, v152, v153
    v_cvt_pk_bf16_f32 v213, v154, v155
    v_cvt_pk_bf16_f32 v214, v156, v157
    v_cvt_pk_bf16_f32 v215, v158, v159
    v_exp_f32_e64 v184, v184 clamp
    v_exp_f32_e64 v185, v185 clamp
    v_exp_f32_e64 v186, v186 clamp
    v_exp_f32_e64 v187, v187 clamp
    v_max_f32 v184, v184, v128
    v_max_f32 v185, v185, v129
    buffer_load_dwordx4 v20, s[88:91], s53 offen offset:1024 lds
    v_max_f32 v186, v186, v130
    v_max_f32 v187, v187, v131
    v_pk_add_f32 v[184:185], v[184:185], v[172:173] op_sel:[0,1]
    v_pk_add_f32 v[186:187], v[186:187], v[172:173] op_sel:[0,1]
    v_cvt_pk_bf16_f32 v200, v184, v185
    v_cvt_pk_bf16_f32 v201, v186, v187
    v_pk_fma_f32 v[184:185], v[132:133], v[172:173], v[172:173] op_sel_hi:[1,0,0] neg_lo:[0,0,1] neg_hi:[0,0,1]
    v_pk_fma_f32 v[186:187], v[134:135], v[172:173], v[172:173] op_sel_hi:[1,0,0] neg_lo:[0,0,1] neg_hi:[0,0,1]
    v_mfma_f32_16x16x32_bf16 v[220:223], v[196:199], v[212:215], v[220:223]
    v_cvt_pk_bf16_f32 v216, v160, v161
    v_cvt_pk_bf16_f32 v217, v162, v163
    v_cvt_pk_bf16_f32 v218, v164, v165
    v_cvt_pk_bf16_f32 v219, v166, v167
    v_exp_f32_e64 v184, v184 clamp
    buffer_load_dwordx4 v19, s[8:11], s53 offen offset:2048 lds
    v_exp_f32_e64 v185, v185 clamp
    v_exp_f32_e64 v186, v186 clamp
    v_exp_f32_e64 v187, v187 clamp
    v_max_f32 v184, v184, v132
    v_max_f32 v185, v185, v133
    v_max_f32 v186, v186, v134
    v_max_f32 v187, v187, v135
    v_pk_add_f32 v[184:185], v[184:185], v[172:173] op_sel:[0,1]
    v_pk_add_f32 v[186:187], v[186:187], v[172:173] op_sel:[0,1]
    v_cvt_pk_bf16_f32 v202, v184, v185
    v_cvt_pk_bf16_f32 v203, v186, v187
    s_nop 1
    v_mfma_f32_16x16x32_bf16 v[228:231], v[200:203], v[176:179], v[228:231]
    v_mfma_f32_16x16x32_bf16 v[220:223], v[200:203], v[216:219], v[220:223]
    v_mov_b32 v226, 0
    v_mov_b32 v227, s43
    s_waitcnt vmcnt(15)
    s_nop 3
    v_cndmask_b32_e64 v225, v228, v229, s[24:25]
    v_cndmask_b32_e64 v225, v225, v230, s[26:27]
    v_cndmask_b32_e64 v225, v225, v231, s[28:29]
    v_mov_b32 v224, v223
    v_mov_b32 v223, s43
    buffer_store_dwordx4 v[220:223], v175, s[80:83], s30 offen sc1
    buffer_store_dwordx4 v[224:227], v175, s[80:83], s30 offen offset:64 sc1
    s_barrier
    ds_read_b64_tr_b16 v[136:137], v40 offset:0
    ds_read_b64_tr_b16 v[138:139], v40 offset:512
    ds_read_b64_tr_b16 v[140:141], v41 offset:0
    ds_read_b64_tr_b16 v[142:143], v41 offset:512
    ds_read_b64_tr_b16 v[144:145], v42 offset:0
    ds_read_b64_tr_b16 v[146:147], v42 offset:512
    ds_read_b64_tr_b16 v[148:149], v43 offset:0
    ds_read_b64_tr_b16 v[150:151], v43 offset:512
    ds_read_b64_tr_b16 v[152:153], v40 offset:4096
    ds_read_b64_tr_b16 v[154:155], v40 offset:4608
    ds_read_b64_tr_b16 v[156:157], v41 offset:4096
    ds_read_b64_tr_b16 v[158:159], v41 offset:4608
    s_waitcnt lgkmcnt(4)
    v_mfma_f32_16x16x32_bf16 v[104:107], v[136:139], a[64:67], 1.0
    ds_read_b64_tr_b16 v[160:161], v42 offset:4096
    v_mul_f32 v60, v76, v60
    v_mfma_f32_16x16x32_bf16 v[120:123], v[136:139], a[128:131], 1.0
    ds_read_b64_tr_b16 v[162:163], v42 offset:4608
    v_mfma_f32_16x16x32_bf16 v[108:111], v[140:143], a[64:67], 1.0
    ds_read_b64_tr_b16 v[164:165], v43 offset:4096
    v_mfma_f32_16x16x32_bf16 v[124:127], v[140:143], a[128:131], 1.0
    ds_read_b64_tr_b16 v[166:167], v43 offset:4608
    v_mul_f32 v61, v76, v61
    v_mfma_f32_16x16x32_bf16 v[112:115], v[144:147], a[64:67], 1.0
    ds_read_b64_tr_b16 v[188:189], v40 offset:8192
    v_mul_f32 v62, v76, v62
    v_mfma_f32_16x16x32_bf16 v[128:131], v[144:147], a[128:131], 1.0
    ds_read_b64_tr_b16 v[190:191], v40 offset:8704
    ds_read_b64_tr_b16 v[192:193], v41 offset:8192
    v_mfma_f32_16x16x32_bf16 v[116:119], v[148:151], a[64:67], 1.0
    buffer_load_dwordx4 v20, s[8:11], s53 offen offset:3072 lds
    v_mfma_f32_16x16x32_bf16 v[132:135], v[148:151], a[128:131], 1.0
    ds_read_b64_tr_b16 v[194:195], v41 offset:8704
    s_waitcnt lgkmcnt(4)
    v_mfma_f32_16x16x32_bf16 v[104:107], v[152:155], a[68:71], v[104:107]
    ds_read_b64_tr_b16 v[196:197], v42 offset:8192
    v_mul_f32 v63, v76, v63
    v_mfma_f32_16x16x32_bf16 v[120:123], v[152:155], a[132:135], v[120:123]
    ds_read_b64_tr_b16 v[198:199], v42 offset:8704
    s_add_u32 m0, s47, 0x18000
    v_mfma_f32_16x16x32_bf16 v[108:111], v[156:159], a[68:71], v[108:111]
    ds_read_b64_tr_b16 v[200:201], v43 offset:8192
    v_mfma_f32_16x16x32_bf16 v[124:127], v[156:159], a[132:135], v[124:127]
    ds_read_b64_tr_b16 v[202:203], v43 offset:8704
    s_add_u32 s53, s22, 0x200
    v_mfma_f32_16x16x32_bf16 v[112:115], v[160:163], a[68:71], v[112:115]
    ds_read_b64_tr_b16 v[136:137], v40 offset:12288
    v_mul_f32 v64, v77, v64
    v_mfma_f32_16x16x32_bf16 v[128:131], v[160:163], a[132:135], v[128:131]
    ds_read_b64_tr_b16 v[138:139], v40 offset:12800
    ds_read_b64_tr_b16 v[140:141], v41 offset:12288
    v_mfma_f32_16x16x32_bf16 v[116:119], v[164:167], a[68:71], v[116:119]
    buffer_load_dwordx4 v19, s[88:91], s53 offen lds
    v_mfma_f32_16x16x32_bf16 v[132:135], v[164:167], a[132:135], v[132:135]
    ds_read_b64_tr_b16 v[142:143], v41 offset:12800
    s_waitcnt lgkmcnt(4)
    v_mfma_f32_16x16x32_bf16 v[104:107], v[188:191], a[72:75], v[104:107]
    ds_read_b64_tr_b16 v[144:145], v42 offset:12288
    v_mul_f32 v65, v77, v65
    v_mfma_f32_16x16x32_bf16 v[120:123], v[188:191], a[136:139], v[120:123]
    ds_read_b64_tr_b16 v[146:147], v42 offset:12800
    v_mfma_f32_16x16x32_bf16 v[108:111], v[192:195], a[72:75], v[108:111]
    ds_read_b64_tr_b16 v[148:149], v43 offset:12288
    v_mfma_f32_16x16x32_bf16 v[124:127], v[192:195], a[136:139], v[124:127]
    ds_read_b64_tr_b16 v[150:151], v43 offset:12800
    v_mul_f32 v66, v77, v66
    v_mfma_f32_16x16x32_bf16 v[112:115], v[196:199], a[72:75], v[112:115]
    ds_read_b64_tr_b16 v[152:153], v40 offset:16384
    v_mul_f32 v67, v77, v67
    v_mfma_f32_16x16x32_bf16 v[128:131], v[196:199], a[136:139], v[128:131]
    ds_read_b64_tr_b16 v[154:155], v40 offset:16896
    ds_read_b64_tr_b16 v[156:157], v41 offset:16384
    v_mfma_f32_16x16x32_bf16 v[116:119], v[200:203], a[72:75], v[116:119]
    buffer_load_dwordx4 v20, s[88:91], s53 offen offset:1024 lds
    v_mfma_f32_16x16x32_bf16 v[132:135], v[200:203], a[136:139], v[132:135]
    ds_read_b64_tr_b16 v[158:159], v41 offset:16896
    s_waitcnt lgkmcnt(4)
    v_mfma_f32_16x16x32_bf16 v[104:107], v[136:139], a[76:79], v[104:107]
    ds_read_b64_tr_b16 v[160:161], v42 offset:16384
    v_mul_f32 v68, v78, v68
    v_mfma_f32_16x16x32_bf16 v[120:123], v[136:139], a[140:143], v[120:123]
    ds_read_b64_tr_b16 v[162:163], v42 offset:16896
    v_mfma_f32_16x16x32_bf16 v[108:111], v[140:143], a[76:79], v[108:111]
    ds_read_b64_tr_b16 v[164:165], v43 offset:16384
    v_mfma_f32_16x16x32_bf16 v[124:127], v[140:143], a[140:143], v[124:127]
    ds_read_b64_tr_b16 v[166:167], v43 offset:16896
    v_mul_f32 v69, v78, v69
    v_mfma_f32_16x16x32_bf16 v[112:115], v[144:147], a[76:79], v[112:115]
    ds_read_b64_tr_b16 v[188:189], v40 offset:20480
    v_mul_f32 v70, v78, v70
    v_mfma_f32_16x16x32_bf16 v[128:131], v[144:147], a[140:143], v[128:131]
    ds_read_b64_tr_b16 v[190:191], v40 offset:20992
    ds_read_b64_tr_b16 v[192:193], v41 offset:20480
    v_mfma_f32_16x16x32_bf16 v[116:119], v[148:151], a[76:79], v[116:119]
    buffer_load_dwordx4 v19, s[8:11], s53 offen offset:2048 lds
    v_mfma_f32_16x16x32_bf16 v[132:135], v[148:151], a[140:143], v[132:135]
    ds_read_b64_tr_b16 v[194:195], v41 offset:20992
    s_waitcnt lgkmcnt(4)
    v_mfma_f32_16x16x32_bf16 v[104:107], v[152:155], a[80:83], v[104:107]
    ds_read_b64_tr_b16 v[196:197], v42 offset:20480
    v_mul_f32 v71, v78, v71
    v_mfma_f32_16x16x32_bf16 v[120:123], v[152:155], a[144:147], v[120:123]
    ds_read_b64_tr_b16 v[198:199], v42 offset:20992
    v_mfma_f32_16x16x32_bf16 v[108:111], v[156:159], a[80:83], v[108:111]
    ds_read_b64_tr_b16 v[200:201], v43 offset:20480
    v_mfma_f32_16x16x32_bf16 v[124:127], v[156:159], a[144:147], v[124:127]
    ds_read_b64_tr_b16 v[202:203], v43 offset:20992
    v_mul_f32 v72, v79, v72
    v_mfma_f32_16x16x32_bf16 v[112:115], v[160:163], a[80:83], v[112:115]
    ds_read_b64_tr_b16 v[136:137], v40 offset:24576
    v_mul_f32 v73, v79, v73
    v_mfma_f32_16x16x32_bf16 v[128:131], v[160:163], a[144:147], v[128:131]
    ds_read_b64_tr_b16 v[138:139], v40 offset:25088
    ds_read_b64_tr_b16 v[140:141], v41 offset:24576
    v_mfma_f32_16x16x32_bf16 v[116:119], v[164:167], a[80:83], v[116:119]
    buffer_load_dwordx4 v20, s[8:11], s53 offen offset:3072 lds
    v_mfma_f32_16x16x32_bf16 v[132:135], v[164:167], a[144:147], v[132:135]
    ds_read_b64_tr_b16 v[142:143], v41 offset:25088
    s_waitcnt lgkmcnt(4)
    v_mfma_f32_16x16x32_bf16 v[104:107], v[188:191], a[84:87], v[104:107]
    ds_read_b64_tr_b16 v[144:145], v42 offset:24576
    v_mul_f32 v74, v79, v74
    v_mfma_f32_16x16x32_bf16 v[120:123], v[188:191], a[148:151], v[120:123]
    ds_read_b64_tr_b16 v[146:147], v42 offset:25088
    s_add_u32 m0, s47, 0x1c000
    v_mfma_f32_16x16x32_bf16 v[108:111], v[192:195], a[84:87], v[108:111]
    ds_read_b64_tr_b16 v[148:149], v43 offset:24576
    v_mfma_f32_16x16x32_bf16 v[124:127], v[192:195], a[148:151], v[124:127]
    ds_read_b64_tr_b16 v[150:151], v43 offset:25088
    buffer_load_dwordx4 v[12:15], v174, s[80:83], s31 offen sc1
    buffer_load_dwordx4 v[24:27], v174, s[80:83], s19 offen sc1
    v_mfma_f32_16x16x32_bf16 v[112:115], v[196:199], a[84:87], v[112:115]
    ds_read_b64_tr_b16 v[152:153], v40 offset:28672
    s_add_u32 s53, s22, 0x280
    v_mfma_f32_16x16x32_bf16 v[128:131], v[196:199], a[148:151], v[128:131]
    ds_read_b64_tr_b16 v[154:155], v40 offset:29184
    ds_read_b64_tr_b16 v[156:157], v41 offset:28672
    v_mfma_f32_16x16x32_bf16 v[116:119], v[200:203], a[84:87], v[116:119]
    buffer_load_dwordx4 v19, s[88:91], s53 offen lds
    v_mfma_f32_16x16x32_bf16 v[132:135], v[200:203], a[148:151], v[132:135]
    ds_read_b64_tr_b16 v[158:159], v41 offset:29184
    s_waitcnt lgkmcnt(4)
    v_mfma_f32_16x16x32_bf16 v[104:107], v[136:139], a[88:91], v[104:107]
    ds_read_b64_tr_b16 v[160:161], v42 offset:28672
    v_mul_f32 v75, v79, v75
    v_mfma_f32_16x16x32_bf16 v[120:123], v[136:139], a[152:155], v[120:123]
    ds_read_b64_tr_b16 v[162:163], v42 offset:29184
    v_mfma_f32_16x16x32_bf16 v[108:111], v[140:143], a[88:91], v[108:111]
    ds_read_b64_tr_b16 v[164:165], v43 offset:28672
    v_mfma_f32_16x16x32_bf16 v[124:127], v[140:143], a[152:155], v[124:127]
    ds_read_b64_tr_b16 v[166:167], v43 offset:29184
    v_mfma_f32_16x16x32_bf16 v[112:115], v[144:147], a[88:91], v[112:115]
    ds_read_b64_tr_b16 v[188:189], v40 offset:32768
    v_mfma_f32_16x16x32_bf16 v[128:131], v[144:147], a[152:155], v[128:131]
    ds_read_b64_tr_b16 v[190:191], v40 offset:33280
    ds_read_b64_tr_b16 v[192:193], v41 offset:32768
    v_mfma_f32_16x16x32_bf16 v[116:119], v[148:151], a[88:91], v[116:119]
    buffer_load_dwordx4 v20, s[88:91], s53 offen offset:1024 lds
    v_mfma_f32_16x16x32_bf16 v[132:135], v[148:151], a[152:155], v[132:135]
    ds_read_b64_tr_b16 v[194:195], v41 offset:33280
    s_waitcnt lgkmcnt(4)
    v_mfma_f32_16x16x32_bf16 v[104:107], v[152:155], a[92:95], v[104:107]
    ds_read_b64_tr_b16 v[196:197], v42 offset:32768
    v_mfma_f32_16x16x32_bf16 v[120:123], v[152:155], a[156:159], v[120:123]
    ds_read_b64_tr_b16 v[198:199], v42 offset:33280
    v_mfma_f32_16x16x32_bf16 v[108:111], v[156:159], a[92:95], v[108:111]
    ds_read_b64_tr_b16 v[200:201], v43 offset:32768
    v_mfma_f32_16x16x32_bf16 v[124:127], v[156:159], a[156:159], v[124:127]
    ds_read_b64_tr_b16 v[202:203], v43 offset:33280
    v_mfma_f32_16x16x32_bf16 v[112:115], v[160:163], a[92:95], v[112:115]
    ds_read_b64_tr_b16 v[136:137], v40 offset:36864
    v_mfma_f32_16x16x32_bf16 v[128:131], v[160:163], a[156:159], v[128:131]
    ds_read_b64_tr_b16 v[138:139], v40 offset:37376
    ds_read_b64_tr_b16 v[140:141], v41 offset:36864
    v_mfma_f32_16x16x32_bf16 v[116:119], v[164:167], a[92:95], v[116:119]
    buffer_load_dwordx4 v19, s[8:11], s53 offen offset:2048 lds
    v_mfma_f32_16x16x32_bf16 v[132:135], v[164:167], a[156:159], v[132:135]
    ds_read_b64_tr_b16 v[142:143], v41 offset:37376
    s_waitcnt lgkmcnt(4)
    s_barrier
    v_mfma_f32_16x16x32_bf16 v[104:107], v[188:191], a[96:99], v[104:107]
    ds_read_b64_tr_b16 v[144:145], v42 offset:36864
    v_mfma_f32_16x16x32_bf16 v[120:123], v[188:191], a[160:163], v[120:123]
    ds_read_b64_tr_b16 v[146:147], v42 offset:37376
    ds_read_b64_tr_b16 v[148:149], v43 offset:36864
    v_mfma_f32_16x16x32_bf16 v[108:111], v[192:195], a[96:99], v[108:111]
    buffer_load_dwordx4 v20, s[8:11], s53 offen offset:3072 lds
    v_mfma_f32_16x16x32_bf16 v[124:127], v[192:195], a[160:163], v[124:127]
    ds_read_b64_tr_b16 v[150:151], v43 offset:37376
    s_add_u32 m0, s47, 0x0
    v_mfma_f32_16x16x32_bf16 v[112:115], v[196:199], a[96:99], v[112:115]
    ds_read_b64_tr_b16 v[152:153], v40 offset:40960
    s_add_u32 s53, s22, 0x300
    v_mfma_f32_16x16x32_bf16 v[128:131], v[196:199], a[160:163], v[128:131]
    ds_read_b64_tr_b16 v[154:155], v40 offset:41472
    ds_read_b64_tr_b16 v[156:157], v41 offset:40960
    v_mfma_f32_16x16x32_bf16 v[116:119], v[200:203], a[96:99], v[116:119]
    buffer_load_dwordx4 v19, s[88:91], s53 offen lds
    v_mfma_f32_16x16x32_bf16 v[132:135], v[200:203], a[160:163], v[132:135]
    ds_read_b64_tr_b16 v[158:159], v41 offset:41472
    s_waitcnt lgkmcnt(4)
    v_mfma_f32_16x16x32_bf16 v[104:107], v[136:139], a[100:103], v[104:107]
    ds_read_b64_tr_b16 v[160:161], v42 offset:40960
    v_mfma_f32_16x16x32_bf16 v[120:123], v[136:139], a[164:167], v[120:123]
    ds_read_b64_tr_b16 v[162:163], v42 offset:41472
    ds_read_b64_tr_b16 v[164:165], v43 offset:40960
    v_mfma_f32_16x16x32_bf16 v[108:111], v[140:143], a[100:103], v[108:111]
    buffer_load_dwordx4 v20, s[88:91], s53 offen offset:1024 lds
    v_mfma_f32_16x16x32_bf16 v[124:127], v[140:143], a[164:167], v[124:127]
    ds_read_b64_tr_b16 v[166:167], v43 offset:41472
    v_mfma_f32_16x16x32_bf16 v[112:115], v[144:147], a[100:103], v[112:115]
    ds_read_b64_tr_b16 v[188:189], v40 offset:45056
    v_mfma_f32_16x16x32_bf16 v[128:131], v[144:147], a[164:167], v[128:131]
    ds_read_b64_tr_b16 v[190:191], v40 offset:45568
    ds_read_b64_tr_b16 v[192:193], v41 offset:45056
    v_mfma_f32_16x16x32_bf16 v[116:119], v[148:151], a[100:103], v[116:119]
    buffer_load_dwordx4 v19, s[8:11], s53 offen offset:2048 lds
    v_mfma_f32_16x16x32_bf16 v[132:135], v[148:151], a[164:167], v[132:135]
    ds_read_b64_tr_b16 v[194:195], v41 offset:45568
    s_branch LX_pg0
.p2align 12
LX_pg0:
    s_mov_b32 s44, 0
    s_waitcnt vmcnt(7)
LX_chk_kv1_1:
    v_cmp_ne_u32_e64 vcc, s43, v15
    v_cmp_ne_u32_e64 s[54:55], s43, v27
    s_nop 0
    s_or_b64 vcc, vcc, s[54:55]
    s_cbranch_vccz LX_ok_kv1_2
    buffer_load_dwordx4 v[12:15], v174, s[80:83], s31 offen sc1
    buffer_load_dwordx4 v[24:27], v174, s[80:83], s19 offen sc1
    s_add_u32 s44, s44, 1
    s_cmp_lt_u32 s44, 0x10000
    s_waitcnt vmcnt(0)
    s_cbranch_scc1 LX_chk_kv1_1
LX_ok_kv1_2:
    s_waitcnt lgkmcnt(4)
    v_mfma_f32_16x16x32_bf16 v[104:107], v[152:155], a[104:107], v[104:107]
    ds_read_b64_tr_b16 v[196:197], v42 offset:45056
    v_add_f32 v12, v12, v24
    v_add_f32 v13, v13, v25
    v_add_f32 v14, v14, v26
    v_add_f32_dpp v12, v12, v12 row_ror:8 row_mask:0xf bank_mask:0xf
    v_add_f32_dpp v13, v13, v13 row_ror:8 row_mask:0xf bank_mask:0xf
    v_add_f32_dpp v14, v14, v14 row_ror:8 row_mask:0xf bank_mask:0xf
    v_mfma_f32_16x16x32_bf16 v[120:123], v[152:155], a[168:171], v[120:123]
    ds_read_b64_tr_b16 v[198:199], v42 offset:45568
    v_mov_b32 v52, v12
    v_mov_b32 v53, v13
    v_mov_b32 v54, v14
    v_permlane16_swap_b32 v12, v52
    v_permlane16_swap_b32 v13, v53
    v_permlane16_swap_b32 v14, v54
    v_mfma_f32_16x16x32_bf16 v[108:111], v[156:159], a[104:107], v[108:111]
    ds_read_b64_tr_b16 v[200:201], v43 offset:45056
    v_add_f32 v12, v12, v52
    v_add_f32 v13, v13, v53
    v_add_f32 v14, v14, v54
    v_mov_b32 v52, v12
    v_mov_b32 v53, v13
    v_mov_b32 v54, v14
    v_mfma_f32_16x16x32_bf16 v[124:127], v[156:159], a[168:171], v[124:127]
    ds_read_b64_tr_b16 v[202:203], v43 offset:45568
    v_permlane32_swap_b32 v12, v52
    v_permlane32_swap_b32 v13, v53
    v_permlane32_swap_b32 v14, v54
    v_add_f32 v12, v12, v52
    v_add_f32 v13, v13, v53
    v_add_f32 v14, v14, v54
    v_mfma_f32_16x16x32_bf16 v[112:115], v[160:163], a[104:107], v[112:115]
    ds_read_b64_tr_b16 v[136:137], v40 offset:49152
    v_mov_b32 v35, s43
    v_mov_b32_dpp v52, v12 row_ror:4 row_mask:0xf bank_mask:0xf
    v_mov_b32_dpp v34, v13 row_ror:4 row_mask:0xf bank_mask:0xf
    v_cvt_pk_bf16_f32 v32, v12, v13
    v_cvt_pk_bf16_f32 v33, v14, v52
    s_mov_b64 exec, 0xf
    buffer_store_dwordx4 v[32:35], v10, s[80:83], s32 offen sc1
    s_mov_b64 exec, -1
    v_mfma_f32_16x16x32_bf16 v[128:131], v[160:163], a[168:171], v[128:131]
    ds_read_b64_tr_b16 v[138:139], v40 offset:49664
    ds_read_b64_tr_b16 v[140:141], v41 offset:49152
    v_mfma_f32_16x16x32_bf16 v[116:119], v[164:167], a[104:107], v[116:119]
    buffer_load_dwordx4 v20, s[8:11], s53 offen offset:3072 lds
    v_mfma_f32_16x16x32_bf16 v[132:135], v[164:167], a[168:171], v[132:135]
    ds_read_b64_tr_b16 v[142:143], v41 offset:49664
    s_waitcnt lgkmcnt(4)
    v_mfma_f32_16x16x32_bf16 v[104:107], v[188:191], a[108:111], v[104:107]
    ds_read_b64_tr_b16 v[144:145], v42 offset:49152
    v_mfma_f32_16x16x32_bf16 v[120:123], v[188:191], a[172:175], v[120:123]
    ds_read_b64_tr_b16 v[146:147], v42 offset:49664
    s_add_u32 m0, s47, 0x4000
    v_mfma_f32_16x16x32_bf16 v[108:111], v[192:195], a[108:111], v[108:111]
    ds_read_b64_tr_b16 v[148:149], v43 offset:49152
    v_mfma_f32_16x16x32_bf16 v[124:127], v[192:195], a[172:175], v[124:127]
    ds_read_b64_tr_b16 v[150:151], v43 offset:49664
    s_add_u32 s53, s22, 0x380
    v_mfma_f32_16x16x32_bf16 v[112:115], v[196:199], a[108:111], v[112:115]
    ds_read_b64_tr_b16 v[152:153], v40 offset:53248
    v_mfma_f32_16x16x32_bf16 v[128:131], v[196:199], a[172:175], v[128:131]
    ds_read_b64_tr_b16 v[154:155], v40 offset:53760
    ds_read_b64_tr_b16 v[156:157], v41 offset:53248
    v_mfma_f32_16x16x32_bf16 v[116:119], v[200:203], a[108:111], v[116:119]
    buffer_load_dwordx4 v19, s[88:91], s53 offen lds
    v_mfma_f32_16x16x32_bf16 v[132:135], v[200:203], a[172:175], v[132:135]
    ds_read_b64_tr_b16 v[158:159], v41 offset:53760
    s_waitcnt lgkmcnt(4)
    s_barrier
    v_mfma_f32_16x16x32_bf16 v[104:107], v[136:139], a[112:115], v[104:107]
    ds_read_b64_tr_b16 v[160:161], v42 offset:53248
    v_mfma_f32_16x16x32_bf16 v[120:123], v[136:139], a[176:179], v[120:123]
    ds_read_b64_tr_b16 v[162:163], v42 offset:53760
    ds_read_b64_tr_b16 v[164:165], v43 offset:53248
    v_mfma_f32_16x16x32_bf16 v[108:111], v[140:143], a[112:115], v[108:111]
    buffer_load_dwordx4 v20, s[88:91], s53 offen offset:1024 lds
    v_mfma_f32_16x16x32_bf16 v[124:127], v[140:143], a[176:179], v[124:127]
    ds_read_b64_tr_b16 v[166:167], v43 offset:53760
    v_mfma_f32_16x16x32_bf16 v[112:115], v[144:147], a[112:115], v[112:115]
    ds_read_b64_tr_b16 v[188:189], v40 offset:57344
    v_mfma_f32_16x16x32_bf16 v[128:131], v[144:147], a[176:179], v[128:131]
    ds_read_b64_tr_b16 v[190:191], v40 offset:57856
    ds_read_b64_tr_b16 v[192:193], v41 offset:57344
    v_mfma_f32_16x16x32_bf16 v[116:119], v[148:151], a[112:115], v[116:119]
    buffer_load_dwordx4 v19, s[8:11], s53 offen offset:2048 lds
    v_mfma_f32_16x16x32_bf16 v[132:135], v[148:151], a[176:179], v[132:135]
    ds_read_b64_tr_b16 v[194:195], v41 offset:57856
    s_waitcnt lgkmcnt(4)
    v_mfma_f32_16x16x32_bf16 v[104:107], v[152:155], a[116:119], v[104:107]
    ds_read_b64_tr_b16 v[196:197], v42 offset:57344
    v_mfma_f32_16x16x32_bf16 v[120:123], v[152:155], a[180:183], v[120:123]
    ds_read_b64_tr_b16 v[198:199], v42 offset:57856
    ds_read_b64_tr_b16 v[200:201], v43 offset:57344
    v_mfma_f32_16x16x32_bf16 v[108:111], v[156:159], a[116:119], v[108:111]
    buffer_load_dwordx4 v20, s[8:11], s53 offen offset:3072 lds
    v_mfma_f32_16x16x32_bf16 v[124:127], v[156:159], a[180:183], v[124:127]
    ds_read_b64_tr_b16 v[202:203], v43 offset:57856
    s_add_u32 m0, s47, 0x8000
    v_mfma_f32_16x16x32_bf16 v[112:115], v[160:163], a[116:119], v[112:115]
    ds_read_b64_tr_b16 v[136:137], v40 offset:61440
    s_add_u32 s53, s23, 0x0
    v_mfma_f32_16x16x32_bf16 v[128:131], v[160:163], a[180:183], v[128:131]
    ds_read_b64_tr_b16 v[138:139], v40 offset:61952
    ds_read_b64_tr_b16 v[140:141], v41 offset:61440
    v_mfma_f32_16x16x32_bf16 v[116:119], v[164:167], a[116:119], v[116:119]
    buffer_load_dwordx4 v21, s[4:7], s53 offen offset:0 lds
    v_mfma_f32_16x16x32_bf16 v[132:135], v[164:167], a[180:183], v[132:135]
    ds_read_b64_tr_b16 v[142:143], v41 offset:61952
    s_waitcnt lgkmcnt(4)
    v_mfma_f32_16x16x32_bf16 v[104:107], v[188:191], a[120:123], v[104:107]
    ds_read_b64_tr_b16 v[144:145], v42 offset:61440
    v_mfma_f32_16x16x32_bf16 v[120:123], v[188:191], a[184:187], v[120:123]
    ds_read_b64_tr_b16 v[146:147], v42 offset:61952
    ds_read_b64_tr_b16 v[148:149], v43 offset:61440
    s_add_u32 s53, s23, 0x1c00
    v_mfma_f32_16x16x32_bf16 v[108:111], v[192:195], a[120:123], v[108:111]
    buffer_load_dwordx4 v21, s[4:7], s53 offen offset:1024 lds
    v_mfma_f32_16x16x32_bf16 v[124:127], v[192:195], a[184:187], v[124:127]
    ds_read_b64_tr_b16 v[150:151], v43 offset:61952
    s_add_u32 s53, s23, 0x3800
    v_mfma_f32_16x16x32_bf16 v[112:115], v[196:199], a[120:123], v[112:115]
    v_mfma_f32_16x16x32_bf16 v[128:131], v[196:199], a[184:187], v[128:131]
    v_mfma_f32_16x16x32_bf16 v[116:119], v[200:203], a[120:123], v[116:119]
    buffer_load_dwordx4 v21, s[4:7], s53 offen offset:2048 lds
    v_mfma_f32_16x16x32_bf16 v[132:135], v[200:203], a[184:187], v[132:135]
    s_waitcnt lgkmcnt(4)
    v_mfma_f32_16x16x32_bf16 v[104:107], v[136:139], a[124:127], v[104:107]
    v_mfma_f32_16x16x32_bf16 v[120:123], v[136:139], a[188:191], v[120:123]
    s_add_u32 s53, s23, 0x5400
    v_mfma_f32_16x16x32_bf16 v[108:111], v[140:143], a[124:127], v[108:111]
    buffer_load_dwordx4 v21, s[4:7], s53 offen offset:3072 lds
    v_mfma_f32_16x16x32_bf16 v[124:127], v[140:143], a[188:191], v[124:127]
    s_waitcnt lgkmcnt(2)
    v_mfma_f32_16x16x32_bf16 v[112:115], v[144:147], a[124:127], v[112:115]
    v_mfma_f32_16x16x32_bf16 v[128:131], v[144:147], a[188:191], v[128:131]
    s_waitcnt lgkmcnt(0)
    v_mfma_f32_16x16x32_bf16 v[116:119], v[148:151], a[124:127], v[116:119]
    v_mfma_f32_16x16x32_bf16 v[132:135], v[148:151], a[188:191], v[132:135]
    s_barrier
    v_pk_fma_f32 v[184:185], v[104:105], v[172:173], v[172:173] op_sel_hi:[1,0,0] neg_lo:[0,0,1] neg_hi:[0,0,1]
    v_pk_fma_f32 v[186:187], v[106:107], v[172:173], v[172:173] op_sel_hi:[1,0,0] neg_lo:[0,0,1] neg_hi:[0,0,1]
    v_mfma_f32_16x16x32_bf16 v[168:171], a[64:67], a[0:3], 0
    v_exp_f32_e64 v184, v184 clamp
    ds_read_b128 a[192:195], v87 offset:0
    v_mfma_f32_16x16x32_bf16 v[168:171], a[68:71], a[4:7], v[168:171]
    v_exp_f32_e64 v185, v185 clamp
    v_mfma_f32_16x16x32_bf16 v[168:171], a[72:75], a[8:11], v[168:171]
    v_exp_f32_e64 v186, v186 clamp
    v_mfma_f32_16x16x32_bf16 v[168:171], a[76:79], a[12:15], v[168:171]
    v_exp_f32_e64 v187, v187 clamp
    ds_read_b128 a[196:199], v87 offset:4096
    v_max_f32 v184, v184, v104
    v_max_f32 v185, v185, v105
    v_max_f32 v186, v186, v106
    ds_read_b128 a[200:203], v87 offset:8192
    v_max_f32 v187, v187, v107
    v_pk_add_f32 v[184:185], v[184:185], v[172:173] op_sel:[0,1]
    v_pk_add_f32 v[186:187], v[186:187], v[172:173] op_sel:[0,1]
    ds_read_b128 a[204:207], v87 offset:12288
    s_add_u32 m0, s47, 0xc000
    s_add_u32 s53, s23, 0x20000
    buffer_load_dwordx4 v21, s[4:7], s53 offen offset:0 lds
    v_cvt_pk_bf16_f32 v136, v184, v185
    v_cvt_pk_bf16_f32 v137, v186, v187
    v_pk_fma_f32 v[184:185], v[108:109], v[172:173], v[172:173] op_sel_hi:[1,0,0] neg_lo:[0,0,1] neg_hi:[0,0,1]
    ds_read_b128 a[208:211], v88 offset:0
    v_pk_fma_f32 v[186:187], v[110:111], v[172:173], v[172:173] op_sel_hi:[1,0,0] neg_lo:[0,0,1] neg_hi:[0,0,1]
    v_mfma_f32_16x16x32_bf16 v[168:171], a[80:83], a[16:19], v[168:171]
    v_exp_f32_e64 v184, v184 clamp
    v_mfma_f32_16x16x32_bf16 v[168:171], a[84:87], a[20:23], v[168:171]
    v_exp_f32_e64 v185, v185 clamp
    ds_read_b128 a[212:215], v88 offset:4096
    v_mfma_f32_16x16x32_bf16 v[168:171], a[88:91], a[24:27], v[168:171]
    v_exp_f32_e64 v186, v186 clamp
    v_mfma_f32_16x16x32_bf16 v[168:171], a[92:95], a[28:31], v[168:171]
    v_exp_f32_e64 v187, v187 clamp
    v_max_f32 v184, v184, v108
    ds_read_b128 a[216:219], v88 offset:8192
    v_max_f32 v185, v185, v109
    v_max_f32 v186, v186, v110
    v_max_f32 v187, v187, v111
    ds_read_b128 a[220:223], v88 offset:12288
    s_add_u32 s53, s23, 0x21c00
    buffer_load_dwordx4 v21, s[4:7], s53 offen offset:1024 lds
    v_pk_add_f32 v[184:185], v[184:185], v[172:173] op_sel:[0,1]
    v_pk_add_f32 v[186:187], v[186:187], v[172:173] op_sel:[0,1]
    v_cvt_pk_bf16_f32 v138, v184, v185
    ds_read_b128 a[224:227], v89 offset:0
    v_cvt_pk_bf16_f32 v139, v186, v187
    v_pk_fma_f32 v[184:185], v[112:113], v[172:173], v[172:173] op_sel_hi:[1,0,0] neg_lo:[0,0,1] neg_hi:[0,0,1]
    v_pk_fma_f32 v[186:187], v[114:115], v[172:173], v[172:173] op_sel_hi:[1,0,0] neg_lo:[0,0,1] neg_hi:[0,0,1]
    ds_read_b128 a[228:231], v89 offset:4096
    v_mfma_f32_16x16x32_bf16 v[168:171], a[96:99], a[32:35], v[168:171]
    v_exp_f32_e64 v184, v184 clamp
    v_mfma_f32_16x16x32_bf16 v[168:171], a[100:103], a[36:39], v[168:171]
    v_exp_f32_e64 v185, v185 clamp
    v_mfma_f32_16x16x32_bf16 v[168:171], a[104:107], a[40:43], v[168:171]
    v_exp_f32_e64 v186, v186 clamp
    ds_read_b128 a[232:235], v89 offset:8192
    v_mfma_f32_16x16x32_bf16 v[168:171], a[108:111], a[44:47], v[168:171]
    v_exp_f32_e64 v187, v187 clamp
    v_max_f32 v184, v184, v112
    v_max_f32 v185, v185, v113
    ds_read_b128 a[236:239], v89 offset:12288
    s_add_u32 s53, s23, 0x23800
    buffer_load_dwordx4 v21, s[4:7], s53 offen offset:2048 lds
    v_max_f32 v186, v186, v114
    v_max_f32 v187, v187, v115
    v_pk_add_f32 v[184:185], v[184:185], v[172:173] op_sel:[0,1]
    ds_read_b128 a[240:243], v90 offset:0
    v_pk_add_f32 v[186:187], v[186:187], v[172:173] op_sel:[0,1]
    v_cvt_pk_bf16_f32 v140, v184, v185
    v_cvt_pk_bf16_f32 v141, v186, v187
    ds_read_b128 a[244:247], v90 offset:4096
    v_pk_fma_f32 v[184:185], v[116:117], v[172:173], v[172:173] op_sel_hi:[1,0,0] neg_lo:[0,0,1] neg_hi:[0,0,1]
    v_pk_fma_f32 v[186:187], v[118:119], v[172:173], v[172:173] op_sel_hi:[1,0,0] neg_lo:[0,0,1] neg_hi:[0,0,1]
    v_mfma_f32_16x16x32_bf16 v[168:171], a[112:115], a[48:51], v[168:171]
    v_exp_f32_e64 v184, v184 clamp
    ds_read_b128 a[248:251], v90 offset:8192
    v_mfma_f32_16x16x32_bf16 v[168:171], a[116:119], a[52:55], v[168:171]
    v_exp_f32_e64 v185, v185 clamp
    v_mfma_f32_16x16x32_bf16 v[168:171], a[120:123], a[56:59], v[168:171]
    v_exp_f32_e64 v186, v186 clamp
    v_mfma_f32_16x16x32_bf16 v[168:171], a[124:127], a[60:63], v[168:171]
    v_exp_f32_e64 v187, v187 clamp
    ds_read_b128 a[252:255], v90 offset:12288
    s_add_u32 s53, s23, 0x25400
    buffer_load_dwordx4 v21, s[4:7], s53 offen offset:3072 lds
    buffer_load_dwordx4 v[152:155], v10, s[80:83], s33 offen offset:0 sc1
    buffer_load_dwordx4 v[156:159], v10, s[80:83], s33 offen offset:1024 sc1
    buffer_load_dwordx4 v[160:163], v10, s[80:83], s33 offen offset:2048 sc1
    buffer_load_dwordx4 v[164:167], v10, s[80:83], s33 offen offset:3072 sc1
    v_max_f32 v184, v184, v116
    v_max_f32 v185, v185, v117
    v_max_f32 v186, v186, v118
    ds_read_b128 a[0:3], v87 offset:16384
    v_max_f32 v187, v187, v119
    v_pk_add_f32 v[184:185], v[184:185], v[172:173] op_sel:[0,1]
    v_pk_add_f32 v[186:187], v[186:187], v[172:173] op_sel:[0,1]
    ds_read_b128 a[4:7], v87 offset:20480
    v_cvt_pk_bf16_f32 v142, v184, v185
    v_cvt_pk_bf16_f32 v143, v186, v187
    v_pk_fma_f32 v[184:185], v[120:121], v[172:173], v[172:173] op_sel_hi:[1,0,0] neg_lo:[0,0,1] neg_hi:[0,0,1]
    ds_read_b128 a[8:11], v87 offset:24576
    v_pk_fma_f32 v[186:187], v[122:123], v[172:173], v[172:173] op_sel_hi:[1,0,0] neg_lo:[0,0,1] neg_hi:[0,0,1]
    v_exp_f32_e64 v184, v184 clamp
    v_exp_f32_e64 v185, v185 clamp
    ds_read_b128 a[12:15], v87 offset:28672
    v_exp_f32_e64 v186, v186 clamp
    v_exp_f32_e64 v187, v187 clamp
    v_max_f32 v184, v184, v120
    ds_read_b128 a[16:19], v88 offset:16384
    v_max_f32 v185, v185, v121
    v_max_f32 v186, v186, v122
    v_max_f32 v187, v187, v123
    ds_read_b128 a[20:23], v88 offset:20480
    v_pk_add_f32 v[184:185], v[184:185], v[172:173] op_sel:[0,1]
    v_pk_add_f32 v[186:187], v[186:187], v[172:173] op_sel:[0,1]
    v_cvt_pk_bf16_f32 v144, v184, v185
    ds_read_b128 a[24:27], v88 offset:24576
    v_cvt_pk_bf16_f32 v145, v186, v187
    v_pk_fma_f32 v[184:185], v[124:125], v[172:173], v[172:173] op_sel_hi:[1,0,0] neg_lo:[0,0,1] neg_hi:[0,0,1]
    v_pk_fma_f32 v[186:187], v[126:127], v[172:173], v[172:173] op_sel_hi:[1,0,0] neg_lo:[0,0,1] neg_hi:[0,0,1]
    ds_read_b128 a[28:31], v88 offset:28672
    v_exp_f32_e64 v184, v184 clamp
    v_exp_f32_e64 v185, v185 clamp
    v_exp_f32_e64 v186, v186 clamp
    ds_read_b128 a[32:35], v89 offset:16384
    v_exp_f32_e64 v187, v187 clamp
    v_max_f32 v184, v184, v124
    v_max_f32 v185, v185, v125
    ds_read_b128 a[36:39], v89 offset:20480
    v_max_f32 v186, v186, v126
    v_max_f32 v187, v187, v127
    v_pk_add_f32 v[184:185], v[184:185], v[172:173] op_sel:[0,1]
    ds_read_b128 a[40:43], v89 offset:24576
    v_pk_add_f32 v[186:187], v[186:187], v[172:173] op_sel:[0,1]
    v_cvt_pk_bf16_f32 v146, v184, v185
    v_cvt_pk_bf16_f32 v147, v186, v187
    ds_read_b128 a[44:47], v89 offset:28672
    v_pk_fma_f32 v[184:185], v[128:129], v[172:173], v[172:173] op_sel_hi:[1,0,0] neg_lo:[0,0,1] neg_hi:[0,0,1]
    v_pk_fma_f32 v[186:187], v[130:131], v[172:173], v[172:173] op_sel_hi:[1,0,0] neg_lo:[0,0,1] neg_hi:[0,0,1]
    v_exp_f32_e64 v184, v184 clamp
    ds_read_b128 a[48:51], v90 offset:16384
    v_exp_f32_e64 v185, v185 clamp
    v_exp_f32_e64 v186, v186 clamp
    v_exp_f32_e64 v187, v187 clamp
    ds_read_b128 a[52:55], v90 offset:20480
    v_max_f32 v184, v184, v128
    v_max_f32 v185, v185, v129
    v_max_f32 v186, v186, v130
    ds_read_b128 a[56:59], v90 offset:24576
    v_max_f32 v187, v187, v131
    v_pk_add_f32 v[184:185], v[184:185], v[172:173] op_sel:[0,1]
    v_pk_add_f32 v[186:187], v[186:187], v[172:173] op_sel:[0,1]
    ds_read_b128 a[60:63], v90 offset:28672
    v_cvt_pk_bf16_f32 v148, v184, v185
    v_cvt_pk_bf16_f32 v149, v186, v187
    v_pk_fma_f32 v[184:185], v[132:133], v[172:173], v[172:173] op_sel_hi:[1,0,0] neg_lo:[0,0,1] neg_hi:[0,0,1]
    v_pk_fma_f32 v[186:187], v[134:135], v[172:173], v[172:173] op_sel_hi:[1,0,0] neg_lo:[0,0,1] neg_hi:[0,0,1]
    v_exp_f32_e64 v184, v184 clamp
    v_exp_f32_e64 v185, v185 clamp
    v_exp_f32_e64 v186, v186 clamp
    v_exp_f32_e64 v187, v187 clamp
    v_max_f32 v184, v184, v132
    v_max_f32 v185, v185, v133
    v_max_f32 v186, v186, v134
    v_max_f32 v187, v187, v135
    v_pk_add_f32 v[184:185], v[184:185], v[172:173] op_sel:[0,1]
    v_pk_add_f32 v[186:187], v[186:187], v[172:173] op_sel:[0,1]
    v_cvt_pk_bf16_f32 v150, v184, v185
    v_cvt_pk_bf16_f32 v151, v186, v187
    s_waitcnt lgkmcnt(0)
    s_barrier
    s_add_u32 m0, s47, 0x20000
    s_add_u32 s53, s23, 0x40000
    buffer_load_dwordx4 v21, s[4:7], s53 offen offset:0 lds
    s_add_u32 s53, s23, 0x41c00
    buffer_load_dwordx4 v21, s[4:7], s53 offen offset:1024 lds
    s_add_u32 s53, s23, 0x43800
    buffer_load_dwordx4 v21, s[4:7], s53 offen offset:2048 lds
    s_add_u32 s53, s23, 0x45400
    buffer_load_dwordx4 v21, s[4:7], s53 offen offset:3072 lds
    s_add_u32 m0, s47, 0x24000
    s_add_u32 s53, s23, 0x60000
    buffer_load_dwordx4 v21, s[4:7], s53 offen offset:0 lds
    s_mov_b32 s44, 0
    s_waitcnt vmcnt(5)
LX_chk_kv2_3:
    v_cmp_ne_u32_e64 vcc, s43, v155
    v_cmp_ne_u32_e64 s[54:55], s43, v159
    s_nop 0
    s_or_b64 vcc, vcc, s[54:55]
    v_cmp_ne_u32_e64 s[54:55], s43, v163
    s_nop 0
    s_or_b64 vcc, vcc, s[54:55]
    v_cmp_ne_u32_e64 s[54:55], s43, v167
    s_nop 0
    s_or_b64 vcc, vcc, s[54:55]
    s_cbranch_vccz LX_ok_kv2_4
    buffer_load_dwordx4 v[152:155], v10, s[80:83], s33 offen offset:0 sc1
    buffer_load_dwordx4 v[156:159], v10, s[80:83], s33 offen offset:1024 sc1
    buffer_load_dwordx4 v[160:163], v10, s[80:83], s33 offen offset:2048 sc1
    buffer_load_dwordx4 v[164:167], v10, s[80:83], s33 offen offset:3072 sc1
    s_add_u32 s44, s44, 1
    s_cmp_lt_u32 s44, 0x10000
    s_waitcnt vmcnt(0)
    s_cbranch_scc1 LX_chk_kv2_3
LX_ok_kv2_4:
    v_mov_b32 v96, 0
    s_mov_b64 exec, 0xff
    buffer_atomic_add v96, v95, s[80:83], s15 offen offset:128 sc0 sc1
    s_mov_b64 exec, -1
    v_mfma_f32_16x16x16_bf16 v[104:107], v[152:153], v[136:137], 0
    v_mov_b32_dpp v184, v154 quad_perm:[0,0,0,0] row_mask:0xf bank_mask:0xf
    v_mov_b32_dpp v185, v154 quad_perm:[1,1,1,1] row_mask:0xf bank_mask:0xf
    v_mov_b32_dpp v186, v154 quad_perm:[2,2,2,2] row_mask:0xf bank_mask:0xf
    v_mfma_f32_16x16x16_bf16 v[120:123], v[152:153], v[144:145], 0
    v_mov_b32_dpp v187, v154 quad_perm:[3,3,3,3] row_mask:0xf bank_mask:0xf
    v_cvt_pk_bf16_f32 v154, v184, v185
    v_cvt_pk_bf16_f32 v155, v186, v187
    s_add_u32 s53, s23, 0x61c00
    buffer_load_dwordx4 v21, s[4:7], s53 offen offset:1024 lds
    v_mfma_f32_16x16x16_bf16 v[108:111], v[156:157], v[138:139], 0
    v_mov_b32_dpp v184, v158 quad_perm:[0,0,0,0] row_mask:0xf bank_mask:0xf
    v_mov_b32_dpp v185, v158 quad_perm:[1,1,1,1] row_mask:0xf bank_mask:0xf
    v_mov_b32_dpp v186, v158 quad_perm:[2,2,2,2] row_mask:0xf bank_mask:0xf
    v_mfma_f32_16x16x16_bf16 v[124:127], v[156:157], v[146:147], 0
    v_mov_b32_dpp v187, v158 quad_perm:[3,3,3,3] row_mask:0xf bank_mask:0xf
    v_cvt_pk_bf16_f32 v158, v184, v185
    v_cvt_pk_bf16_f32 v159, v186, v187
    v_mfma_f32_16x16x16_bf16 v[188:191], v[154:155], v[136:137], v[180:183]
    s_add_u32 s53, s23, 0x63800
    buffer_load_dwordx4 v21, s[4:7], s53 offen offset:2048 lds
    v_mfma_f32_16x16x16_bf16 v[112:115], v[160:161], v[140:141], 0
    v_mov_b32_dpp v184, v162 quad_perm:[0,0,0,0] row_mask:0xf bank_mask:0xf
    v_mov_b32_dpp v185, v162 quad_perm:[1,1,1,1] row_mask:0xf bank_mask:0xf
    v_mov_b32_dpp v186, v162 quad_perm:[2,2,2,2] row_mask:0xf bank_mask:0xf
    v_mfma_f32_16x16x16_bf16 v[128:131], v[160:161], v[148:149], 0
    v_mov_b32_dpp v187, v162 quad_perm:[3,3,3,3] row_mask:0xf bank_mask:0xf
    v_cvt_pk_bf16_f32 v162, v184, v185
    v_cvt_pk_bf16_f32 v163, v186, v187
    v_mfma_f32_16x16x16_bf16 v[192:195], v[158:159], v[138:139], v[180:183]
    s_add_u32 s53, s23, 0x65400
    buffer_load_dwordx4 v21, s[4:7], s53 offen offset:3072 lds
    v_mfma_f32_16x16x16_bf16 v[116:119], v[164:165], v[142:143], 0
    v_mov_b32_dpp v184, v166 quad_perm:[0,0,0,0] row_mask:0xf bank_mask:0xf
    v_mov_b32_dpp v185, v166 quad_perm:[1,1,1,1] row_mask:0xf bank_mask:0xf
    v_mov_b32_dpp v186, v166 quad_perm:[2,2,2,2] row_mask:0xf bank_mask:0xf
    v_mfma_f32_16x16x16_bf16 v[132:135], v[164:165], v[150:151], 0
    v_mov_b32_dpp v187, v166 quad_perm:[3,3,3,3] row_mask:0xf bank_mask:0xf
    v_cvt_pk_bf16_f32 v166, v184, v185
    v_cvt_pk_bf16_f32 v167, v186, v187
    v_mfma_f32_16x16x16_bf16 v[196:199], v[162:163], v[140:141], v[180:183]
    v_rcp_f32 v188, v188
    v_mfma_f32_16x16x16_bf16 v[200:203], v[166:167], v[142:143], v[180:183]
    v_mul_f32 v104, v188, v104
    v_mul_f32 v105, v188, v105
    v_mul_f32 v106, v188, v106
    v_mul_f32 v107, v188, v107
    v_mfma_f32_16x16x16_bf16 v[204:207], v[154:155], v[144:145], v[180:183]
    v_cvt_pk_bf16_f32 v232, v104, v105
    v_cvt_pk_bf16_f32 v233, v106, v107
    v_rcp_f32 v192, v192
    v_mfma_f32_16x16x16_bf16 v[208:211], v[158:159], v[146:147], v[180:183]
    v_mul_f32 v108, v192, v108
    v_mul_f32 v109, v192, v109
    v_mul_f32 v110, v192, v110
    v_mul_f32 v111, v192, v111
    v_mfma_f32_16x16x16_bf16 v[212:215], v[162:163], v[148:149], v[180:183]
    v_cvt_pk_bf16_f32 v234, v108, v109
    v_cvt_pk_bf16_f32 v235, v110, v111
    buffer_store_dwordx4 v[232:235], v98, s[80:83], s34 offen sc1
    v_rcp_f32 v196, v196
    v_mfma_f32_16x16x16_bf16 v[216:219], v[166:167], v[150:151], v[180:183]
    v_mul_f32 v112, v196, v112
    v_mul_f32 v113, v196, v113
    v_mul_f32 v114, v196, v114
    v_mul_f32 v115, v196, v115
    v_cvt_pk_bf16_f32 v236, v112, v113
    v_cvt_pk_bf16_f32 v237, v114, v115
    v_rcp_f32 v200, v200
    s_nop 0
    v_mul_f32 v116, v200, v116
    v_mul_f32 v117, v200, v117
    v_mul_f32 v118, v200, v118
    v_mul_f32 v119, v200, v119
    v_cvt_pk_bf16_f32 v238, v116, v117
    v_cvt_pk_bf16_f32 v239, v118, v119
    buffer_store_dwordx4 v[236:239], v98, s[80:83], s35 offen sc1
    v_rcp_f32 v204, v204
    s_nop 0
    v_pk_mul_f32 v[120:121], v[120:121], v[204:205] op_sel_hi:[1,0]
    v_pk_mul_f32 v[122:123], v[122:123], v[204:205] op_sel_hi:[1,0]
    v_cvt_pk_bf16_f32 v240, v120, v121
    v_cvt_pk_bf16_f32 v241, v122, v123
    v_rcp_f32 v208, v208
    s_nop 0
    v_pk_mul_f32 v[124:125], v[124:125], v[208:209] op_sel_hi:[1,0]
    v_pk_mul_f32 v[126:127], v[126:127], v[208:209] op_sel_hi:[1,0]
    v_cvt_pk_bf16_f32 v242, v124, v125
    v_cvt_pk_bf16_f32 v243, v126, v127
    buffer_store_dwordx4 v[240:243], v98, s[80:83], s77 offen sc1
    v_rcp_f32 v212, v212
    s_nop 0
    v_pk_mul_f32 v[128:129], v[128:129], v[212:213] op_sel_hi:[1,0]
    v_pk_mul_f32 v[130:131], v[130:131], v[212:213] op_sel_hi:[1,0]
    v_cvt_pk_bf16_f32 v244, v128, v129
    v_cvt_pk_bf16_f32 v245, v130, v131
    v_rcp_f32 v216, v216
    s_nop 0
    v_pk_mul_f32 v[132:133], v[132:133], v[216:217] op_sel_hi:[1,0]
    v_pk_mul_f32 v[134:135], v[134:135], v[216:217] op_sel_hi:[1,0]
    v_cvt_pk_bf16_f32 v246, v132, v133
    v_cvt_pk_bf16_f32 v247, v134, v135
    buffer_store_dwordx4 v[244:247], v98, s[80:83], s78 offen sc1
    s_mov_b32 s44, 0
    s_waitcnt vmcnt(7)
LX_chk_fh_5:
    v_cmp_ne_u32 vcc, s43, v96
    s_nop 0
    s_and_b64 vcc, vcc, 0xff
    s_cbranch_vccz LX_ok_fh_6
    v_mov_b32 v96, 0
    s_mov_b64 exec, 0xff
    buffer_atomic_add v96, v95, s[80:83], s15 offen offset:128 sc0 sc1
    s_mov_b64 exec, -1
    s_add_u32 s44, s44, 1
    s_cmp_lt_u32 s44, 0x10000
    s_waitcnt vmcnt(0)
    s_cbranch_scc1 LX_chk_fh_5
LX_ok_fh_6:
    buffer_load_dwordx4 a[128:131], v98, s[80:83], s14 offen offset:0 sc1
    v_mul_f32 v168, 0xbfb8aa3b, v168
    ds_read_b128 a[64:67], v83 offset:0
    v_mul_f32 v169, 0xbfb8aa3b, v169
    ds_read_b128 a[68:71], v83 offset:4096
    v_mul_f32 v170, 0xbfb8aa3b, v170
    ds_read_b128 a[72:75], v83 offset:8192
    v_mul_f32 v171, 0xbfb8aa3b, v171
    ds_read_b128 a[76:79], v83 offset:12288
    buffer_load_dwordx4 a[132:135], v98, s[80:83], s14 offen offset:128 sc1
    v_exp_f32 v168, v168
    ds_read_b128 a[80:83], v84 offset:0
    v_exp_f32 v169, v169
    ds_read_b128 a[84:87], v84 offset:4096
    v_exp_f32 v170, v170
    ds_read_b128 a[88:91], v84 offset:8192
    v_exp_f32 v171, v171
    ds_read_b128 a[92:95], v84 offset:12288
    buffer_load_dwordx4 a[136:139], v98, s[80:83], s14 offen offset:256 sc1
    v_add_f32 v168, 1.0, v168
    ds_read_b128 a[96:99], v85 offset:0
    v_add_f32 v169, 1.0, v169
    ds_read_b128 a[100:103], v85 offset:4096
    v_add_f32 v170, 1.0, v170
    ds_read_b128 a[104:107], v85 offset:8192
    v_add_f32 v171, 1.0, v171
    ds_read_b128 a[108:111], v85 offset:12288
    buffer_load_dwordx4 a[140:143], v98, s[80:83], s14 offen offset:512 sc1
    v_rcp_f32 v168, v168
    ds_read_b128 a[112:115], v86 offset:0
    v_rcp_f32 v169, v169
    ds_read_b128 a[116:119], v86 offset:4096
    v_rcp_f32 v170, v170
    ds_read_b128 a[120:123], v86 offset:8192
    v_rcp_f32 v171, v171
    ds_read_b128 a[124:127], v86 offset:12288
    buffer_load_dwordx4 a[144:147], v98, s[80:83], s14 offen offset:640 sc1
    buffer_load_dwordx4 a[148:151], v98, s[80:83], s14 offen offset:768 sc1
    s_addk_i32 s14, 0x2000
    buffer_load_dwordx4 a[152:155], v98, s[80:83], s14 offen offset:0 sc1
    buffer_load_dwordx4 a[156:159], v98, s[80:83], s14 offen offset:128 sc1
    s_waitcnt vmcnt(8)
    s_barrier
    s_cmp_lg_u32 s3, 0
    s_cbranch_scc1 LX_nosend_7
    s_mov_b64 exec, 0xffff
    buffer_atomic_swap v101, v99, s[80:83], s16 offen offset:256 sc1
    s_mov_b64 exec, -1
LX_nosend_7:
    s_waitcnt vmcnt(7)
    v_mfma_f32_16x16x32_bf16 v[60:63], a[128:131], a[192:195], v[60:63]
    s_waitcnt vmcnt(6)
    buffer_load_dwordx4 a[160:163], v98, s[80:83], s14 offen offset:256 sc1
    v_mfma_f32_16x16x32_bf16 v[64:67], a[128:131], a[196:199], v[64:67]
    v_mfma_f32_16x16x32_bf16 v[68:71], a[128:131], a[200:203], v[68:71]
    buffer_load_dwordx4 a[164:167], v98, s[80:83], s14 offen offset:512 sc1
    v_mfma_f32_16x16x32_bf16 v[72:75], a[128:131], a[204:207], v[72:75]
    v_mfma_f32_16x16x32_bf16 v[60:63], a[132:135], a[208:211], v[60:63]
    s_waitcnt vmcnt(7)
    ds_read_b128 a[192:195], v83 offset:16384
    buffer_load_dwordx4 a[168:171], v98, s[80:83], s14 offen offset:640 sc1
    v_mfma_f32_16x16x32_bf16 v[64:67], a[132:135], a[212:215], v[64:67]
    ds_read_b128 a[196:199], v83 offset:20480
    ds_read_b128 a[200:203], v83 offset:24576
    v_mfma_f32_16x16x32_bf16 v[68:71], a[132:135], a[216:219], v[68:71]
    buffer_load_dwordx4 a[172:175], v98, s[80:83], s14 offen offset:768 sc1
    v_mfma_f32_16x16x32_bf16 v[72:75], a[132:135], a[220:223], v[72:75]
    ds_read_b128 a[204:207], v83 offset:28672
    v_mfma_f32_16x16x32_bf16 v[60:63], a[136:139], a[224:227], v[60:63]
    s_waitcnt vmcnt(8)
    ds_read_b128 a[208:211], v84 offset:16384
    s_addk_i32 s14, 0x2000
    buffer_load_dwordx4 a[176:179], v98, s[80:83], s14 offen offset:0 sc1
    v_mfma_f32_16x16x32_bf16 v[64:67], a[136:139], a[228:231], v[64:67]
    ds_read_b128 a[212:215], v84 offset:20480
    ds_read_b128 a[216:219], v84 offset:24576
    v_mfma_f32_16x16x32_bf16 v[68:71], a[136:139], a[232:235], v[68:71]
    buffer_load_dwordx4 a[180:183], v98, s[80:83], s14 offen offset:128 sc1
    v_mfma_f32_16x16x32_bf16 v[72:75], a[136:139], a[236:239], v[72:75]
    ds_read_b128 a[220:223], v84 offset:28672
    s_branch LX_pg1
.p2align 12
LX_pg1:
    v_mfma_f32_16x16x32_bf16 v[60:63], a[140:143], a[240:243], v[60:63]
    s_waitcnt vmcnt(9)
    ds_read_b128 a[224:227], v85 offset:16384
    v_mfma_f32_16x16x32_bf16 v[64:67], a[140:143], a[244:247], v[64:67]
    ds_read_b128 a[228:231], v85 offset:20480
    ds_read_b128 a[232:235], v85 offset:24576
    v_mfma_f32_16x16x32_bf16 v[68:71], a[140:143], a[248:251], v[68:71]
    buffer_load_dwordx4 a[184:187], v98, s[80:83], s14 offen offset:256 sc1
    v_mfma_f32_16x16x32_bf16 v[72:75], a[140:143], a[252:255], v[72:75]
    ds_read_b128 a[236:239], v85 offset:28672
    v_mfma_f32_16x16x32_bf16 v[60:63], a[144:147], a[0:3], v[60:63]
    s_waitcnt vmcnt(9)
    ds_read_b128 a[240:243], v86 offset:16384
    v_mfma_f32_16x16x32_bf16 v[64:67], a[144:147], a[4:7], v[64:67]
    ds_read_b128 a[244:247], v86 offset:20480
    ds_read_b128 a[248:251], v86 offset:24576
    v_mfma_f32_16x16x32_bf16 v[68:71], a[144:147], a[8:11], v[68:71]
    buffer_load_dwordx4 a[188:191], v98, s[80:83], s14 offen offset:512 sc1
    v_mfma_f32_16x16x32_bf16 v[72:75], a[144:147], a[12:15], v[72:75]
    ds_read_b128 a[252:255], v86 offset:28672
    v_mfma_f32_16x16x32_bf16 v[60:63], a[148:151], a[16:19], v[60:63]
    s_waitcnt vmcnt(9)
    ds_read_b128 a[0:3], v83 offset:32768
    v_mfma_f32_16x16x32_bf16 v[64:67], a[148:151], a[20:23], v[64:67]
    ds_read_b128 a[4:7], v83 offset:36864
    ds_read_b128 a[8:11], v83 offset:40960
    v_mfma_f32_16x16x32_bf16 v[68:71], a[148:151], a[24:27], v[68:71]
    buffer_load_dwordx4 a[128:131], v98, s[80:83], s14 offen offset:640 sc1
    v_mfma_f32_16x16x32_bf16 v[72:75], a[148:151], a[28:31], v[72:75]
    ds_read_b128 a[12:15], v83 offset:45056
    v_mfma_f32_16x16x32_bf16 v[60:63], a[152:155], a[32:35], v[60:63]
    s_waitcnt vmcnt(9)
    ds_read_b128 a[16:19], v84 offset:32768
    v_mfma_f32_16x16x32_bf16 v[64:67], a[152:155], a[36:39], v[64:67]
    ds_read_b128 a[20:23], v84 offset:36864
    ds_read_b128 a[24:27], v84 offset:40960
    v_mfma_f32_16x16x32_bf16 v[68:71], a[152:155], a[40:43], v[68:71]
    buffer_load_dwordx4 a[132:135], v98, s[80:83], s14 offen offset:768 sc1
    v_mfma_f32_16x16x32_bf16 v[72:75], a[152:155], a[44:47], v[72:75]
    ds_read_b128 a[28:31], v84 offset:45056
    v_mfma_f32_16x16x32_bf16 v[60:63], a[156:159], a[48:51], v[60:63]
    s_waitcnt vmcnt(9) lgkmcnt(15)
    ds_read_b128 a[32:35], v85 offset:32768
    v_mfma_f32_16x16x32_bf16 v[64:67], a[156:159], a[52:55], v[64:67]
    ds_read_b128 a[36:39], v85 offset:36864
    ds_read_b128 a[40:43], v85 offset:40960
    v_mfma_f32_16x16x32_bf16 v[68:71], a[156:159], a[56:59], v[68:71]
    s_addk_i32 s14, 0x2000
    buffer_load_dwordx4 a[136:139], v98, s[80:83], s14 offen offset:0 sc1
    v_mfma_f32_16x16x32_bf16 v[72:75], a[156:159], a[60:63], v[72:75]
    ds_read_b128 a[44:47], v85 offset:45056
    v_mfma_f32_16x16x32_bf16 v[60:63], a[160:163], a[64:67], v[60:63]
    s_waitcnt vmcnt(9)
    ds_read_b128 a[48:51], v86 offset:32768
    v_mfma_f32_16x16x32_bf16 v[64:67], a[160:163], a[68:71], v[64:67]
    ds_read_b128 a[52:55], v86 offset:36864
    ds_read_b128 a[56:59], v86 offset:40960
    v_mfma_f32_16x16x32_bf16 v[68:71], a[160:163], a[72:75], v[68:71]
    buffer_load_dwordx4 a[140:143], v98, s[80:83], s14 offen offset:128 sc1
    v_mfma_f32_16x16x32_bf16 v[72:75], a[160:163], a[76:79], v[72:75]
    ds_read_b128 a[60:63], v86 offset:45056
    v_mfma_f32_16x16x32_bf16 v[60:63], a[164:167], a[80:83], v[60:63]
    s_waitcnt vmcnt(9)
    ds_read_b128 a[64:67], v83 offset:49152
    v_mfma_f32_16x16x32_bf16 v[64:67], a[164:167], a[84:87], v[64:67]
    ds_read_b128 a[68:71], v83 offset:53248
    ds_read_b128 a[72:75], v83 offset:57344
    v_mfma_f32_16x16x32_bf16 v[68:71], a[164:167], a[88:91], v[68:71]
    buffer_load_dwordx4 a[144:147], v98, s[80:83], s14 offen offset:256 sc1
    v_mfma_f32_16x16x32_bf16 v[72:75], a[164:167], a[92:95], v[72:75]
    ds_read_b128 a[76:79], v83 offset:61440
    v_mfma_f32_16x16x32_bf16 v[60:63], a[168:171], a[96:99], v[60:63]
    s_waitcnt vmcnt(9)
    ds_read_b128 a[80:83], v84 offset:49152
    v_mfma_f32_16x16x32_bf16 v[64:67], a[168:171], a[100:103], v[64:67]
    ds_read_b128 a[84:87], v84 offset:53248
    ds_read_b128 a[88:91], v84 offset:57344
    v_mfma_f32_16x16x32_bf16 v[68:71], a[168:171], a[104:107], v[68:71]
    buffer_load_dwordx4 a[148:151], v98, s[80:83], s14 offen offset:512 sc1
    v_mfma_f32_16x16x32_bf16 v[72:75], a[168:171], a[108:111], v[72:75]
    ds_read_b128 a[92:95], v84 offset:61440
    v_mfma_f32_16x16x32_bf16 v[60:63], a[172:175], a[112:115], v[60:63]
    s_waitcnt vmcnt(9)
    ds_read_b128 a[96:99], v85 offset:49152
    v_mfma_f32_16x16x32_bf16 v[64:67], a[172:175], a[116:119], v[64:67]
    ds_read_b128 a[100:103], v85 offset:53248
    ds_read_b128 a[104:107], v85 offset:57344
    v_mfma_f32_16x16x32_bf16 v[68:71], a[172:175], a[120:123], v[68:71]
    v_mov_b32 v97, 0
    s_mov_b64 exec, 0xff
    buffer_atomic_add v97, v95, s[80:83], s18 offen offset:256 sc0 sc1
    s_mov_b64 exec, -1
    buffer_load_dwordx4 a[152:155], v98, s[80:83], s14 offen offset:640 sc1
    v_mfma_f32_16x16x32_bf16 v[72:75], a[172:175], a[124:127], v[72:75]
    ds_read_b128 a[108:111], v85 offset:61440
    v_mfma_f32_16x16x32_bf16 v[60:63], a[176:179], a[192:195], v[60:63]
    s_waitcnt vmcnt(10)
    ds_read_b128 a[112:115], v86 offset:49152
    v_mfma_f32_16x16x32_bf16 v[64:67], a[176:179], a[196:199], v[64:67]
    ds_read_b128 a[116:119], v86 offset:53248
    ds_read_b128 a[120:123], v86 offset:57344
    v_mfma_f32_16x16x32_bf16 v[68:71], a[176:179], a[200:203], v[68:71]
    buffer_load_dwordx4 a[156:159], v98, s[80:83], s14 offen offset:768 sc1
    v_mfma_f32_16x16x32_bf16 v[72:75], a[176:179], a[204:207], v[72:75]
    ds_read_b128 a[124:127], v86 offset:61440
    v_mfma_f32_16x16x32_bf16 v[60:63], a[180:183], a[208:211], v[60:63]
    s_waitcnt vmcnt(10) lgkmcnt(15)
    ds_read_b128 a[192:195], v59 offset:0
    v_mfma_f32_16x16x32_bf16 v[64:67], a[180:183], a[212:215], v[64:67]
    ds_read_b128 a[196:199], v59 offset:4096
    ds_read_b128 a[200:203], v59 offset:8192
    v_mfma_f32_16x16x32_bf16 v[68:71], a[180:183], a[216:219], v[68:71]
    s_addk_i32 s14, 0x2000
    buffer_load_dwordx4 a[160:163], v98, s[80:83], s14 offen offset:0 sc1
    v_mfma_f32_16x16x32_bf16 v[72:75], a[180:183], a[220:223], v[72:75]
    ds_read_b128 a[204:207], v59 offset:12288
    v_mfma_f32_16x16x32_bf16 v[60:63], a[184:187], a[224:227], v[60:63]
    s_waitcnt vmcnt(10)
    ds_read_b128 a[208:211], v80 offset:0
    v_mfma_f32_16x16x32_bf16 v[64:67], a[184:187], a[228:231], v[64:67]
    ds_read_b128 a[212:215], v80 offset:4096
    ds_read_b128 a[216:219], v80 offset:8192
    v_mfma_f32_16x16x32_bf16 v[68:71], a[184:187], a[232:235], v[68:71]
    buffer_load_dwordx4 a[164:167], v98, s[80:83], s14 offen offset:128 sc1
    v_mfma_f32_16x16x32_bf16 v[72:75], a[184:187], a[236:239], v[72:75]
    ds_read_b128 a[220:223], v80 offset:12288
    v_mfma_f32_16x16x32_bf16 v[60:63], a[188:191], a[240:243], v[60:63]
    s_waitcnt vmcnt(10)
    ds_read_b128 a[224:227], v81 offset:0
    v_mfma_f32_16x16x32_bf16 v[64:67], a[188:191], a[244:247], v[64:67]
    ds_read_b128 a[228:231], v81 offset:4096
    ds_read_b128 a[232:235], v81 offset:8192
    v_mfma_f32_16x16x32_bf16 v[68:71], a[188:191], a[248:251], v[68:71]
    buffer_load_dwordx4 a[168:171], v98, s[80:83], s14 offen offset:256 sc1
    v_mfma_f32_16x16x32_bf16 v[72:75], a[188:191], a[252:255], v[72:75]
    ds_read_b128 a[236:239], v81 offset:12288
    v_mfma_f32_16x16x32_bf16 v[60:63], a[128:131], a[0:3], v[60:63]
    s_waitcnt vmcnt(10)
    ds_read_b128 a[240:243], v82 offset:0
    v_mfma_f32_16x16x32_bf16 v[64:67], a[128:131], a[4:7], v[64:67]
    ds_read_b128 a[244:247], v82 offset:4096
    ds_read_b128 a[248:251], v82 offset:8192
    v_mfma_f32_16x16x32_bf16 v[68:71], a[128:131], a[8:11], v[68:71]
    buffer_load_dwordx4 a[172:175], v98, s[80:83], s14 offen offset:512 sc1
    v_mfma_f32_16x16x32_bf16 v[72:75], a[128:131], a[12:15], v[72:75]
    ds_read_b128 a[252:255], v82 offset:12288
    v_mfma_f32_16x16x32_bf16 v[60:63], a[132:135], a[16:19], v[60:63]
    s_waitcnt vmcnt(10)
    ds_read_b128 a[0:3], v59 offset:16384
    v_mfma_f32_16x16x32_bf16 v[64:67], a[132:135], a[20:23], v[64:67]
    ds_read_b128 a[4:7], v59 offset:20480
    ds_read_b128 a[8:11], v59 offset:24576
    v_mfma_f32_16x16x32_bf16 v[68:71], a[132:135], a[24:27], v[68:71]
    buffer_load_dwordx4 a[176:179], v98, s[80:83], s14 offen offset:640 sc1
    v_mfma_f32_16x16x32_bf16 v[72:75], a[132:135], a[28:31], v[72:75]
    ds_read_b128 a[12:15], v59 offset:28672
    v_mfma_f32_16x16x32_bf16 v[60:63], a[136:139], a[32:35], v[60:63]
    s_waitcnt vmcnt(10)
    ds_read_b128 a[16:19], v80 offset:16384
    v_mfma_f32_16x16x32_bf16 v[64:67], a[136:139], a[36:39], v[64:67]
    ds_read_b128 a[20:23], v80 offset:20480
    ds_read_b128 a[24:27], v80 offset:24576
    v_mfma_f32_16x16x32_bf16 v[68:71], a[136:139], a[40:43], v[68:71]
    buffer_load_dwordx4 a[180:183], v98, s[80:83], s14 offen offset:768 sc1
    v_mfma_f32_16x16x32_bf16 v[72:75], a[136:139], a[44:47], v[72:75]
    ds_read_b128 a[28:31], v80 offset:28672
    v_mfma_f32_16x16x32_bf16 v[60:63], a[140:143], a[48:51], v[60:63]
    s_waitcnt vmcnt(10) lgkmcnt(15)
    ds_read_b128 a[32:35], v81 offset:16384
    v_mfma_f32_16x16x32_bf16 v[64:67], a[140:143], a[52:55], v[64:67]
    ds_read_b128 a[36:39], v81 offset:20480
    ds_read_b128 a[40:43], v81 offset:24576
    v_mfma_f32_16x16x32_bf16 v[68:71], a[140:143], a[56:59], v[68:71]
    s_addk_i32 s14, 0x2000
    buffer_load_dwordx4 a[184:187], v98, s[80:83], s14 offen offset:0 sc1
    v_mfma_f32_16x16x32_bf16 v[72:75], a[140:143], a[60:63], v[72:75]
    ds_read_b128 a[44:47], v81 offset:28672
    v_mfma_f32_16x16x32_bf16 v[60:63], a[144:147], a[64:67], v[60:63]
    s_waitcnt vmcnt(10)
    ds_read_b128 a[48:51], v82 offset:16384
    v_mfma_f32_16x16x32_bf16 v[64:67], a[144:147], a[68:71], v[64:67]
    ds_read_b128 a[52:55], v82 offset:20480
    ds_read_b128 a[56:59], v82 offset:24576
    v_mfma_f32_16x16x32_bf16 v[68:71], a[144:147], a[72:75], v[68:71]
    buffer_load_dwordx4 a[188:191], v98, s[80:83], s14 offen offset:128 sc1
    v_mfma_f32_16x16x32_bf16 v[72:75], a[144:147], a[76:79], v[72:75]
    ds_read_b128 a[60:63], v82 offset:28672
    v_mfma_f32_16x16x32_bf16 v[60:63], a[148:151], a[80:83], v[60:63]
    s_waitcnt vmcnt(9)
    ds_read_b64_tr_b16 a[64:65], v91 offset:0
    ds_read_b64_tr_b16 a[66:67], v91 offset:2048
    v_mfma_f32_16x16x32_bf16 v[64:67], a[148:151], a[84:87], v[64:67]
    ds_read_b64_tr_b16 a[68:69], v92 offset:0
    ds_read_b64_tr_b16 a[70:71], v92 offset:2048
    v_mfma_f32_16x16x32_bf16 v[68:71], a[148:151], a[88:91], v[68:71]
    s_mov_b32 s44, 0
LX_chk_fo_8:
    v_cmp_ne_u32 vcc, s43, v97
    s_nop 0
    s_and_b64 vcc, vcc, 0xff
    s_cbranch_vccz LX_ok_fo_9
    v_mov_b32 v97, 0
    s_mov_b64 exec, 0xff
    buffer_atomic_add v97, v95, s[80:83], s18 offen offset:256 sc0 sc1
    s_mov_b64 exec, -1
    s_add_u32 s44, s44, 1
    s_cmp_lt_u32 s44, 0x10000
    s_waitcnt vmcnt(0)
    s_cbranch_scc1 LX_chk_fo_8
LX_ok_fo_9:
    buffer_load_dwordx4 a[128:131], v98, s[80:83], s14 offen offset:256 sc1
    v_mfma_f32_16x16x32_bf16 v[72:75], a[148:151], a[92:95], v[72:75]
    ds_read_b64_tr_b16 a[72:73], v93 offset:0
    ds_read_b64_tr_b16 a[74:75], v93 offset:2048
    v_mfma_f32_16x16x32_bf16 v[60:63], a[152:155], a[96:99], v[60:63]
    s_waitcnt vmcnt(9)
    ds_read_b64_tr_b16 a[76:77], v94 offset:0
    ds_read_b64_tr_b16 a[78:79], v94 offset:2048
    v_mfma_f32_16x16x32_bf16 v[64:67], a[152:155], a[100:103], v[64:67]
    ds_read_b64_tr_b16 a[80:81], v91 offset:4096
    ds_read_b64_tr_b16 a[82:83], v91 offset:6144
    v_mfma_f32_16x16x32_bf16 v[68:71], a[152:155], a[104:107], v[68:71]
    buffer_load_dwordx4 a[132:135], v98, s[80:83], s14 offen offset:512 sc1
    v_mfma_f32_16x16x32_bf16 v[72:75], a[152:155], a[108:111], v[72:75]
    ds_read_b64_tr_b16 a[84:85], v92 offset:4096
    ds_read_b64_tr_b16 a[86:87], v92 offset:6144
    v_mfma_f32_16x16x32_bf16 v[60:63], a[156:159], a[112:115], v[60:63]
    s_waitcnt vmcnt(9)
    ds_read_b64_tr_b16 a[88:89], v93 offset:4096
    ds_read_b64_tr_b16 a[90:91], v93 offset:6144
    v_mfma_f32_16x16x32_bf16 v[64:67], a[156:159], a[116:119], v[64:67]
    ds_read_b64_tr_b16 a[92:93], v94 offset:4096
    ds_read_b64_tr_b16 a[94:95], v94 offset:6144
    v_mfma_f32_16x16x32_bf16 v[68:71], a[156:159], a[120:123], v[68:71]
    buffer_load_dwordx4 a[136:139], v98, s[80:83], s14 offen offset:640 sc1
    v_mfma_f32_16x16x32_bf16 v[72:75], a[156:159], a[124:127], v[72:75]
    ds_read_b64_tr_b16 a[96:97], v91 offset:8192
    ds_read_b64_tr_b16 a[98:99], v91 offset:10240
    v_mfma_f32_16x16x32_bf16 v[60:63], a[160:163], a[192:195], v[60:63]
    s_waitcnt vmcnt(9)
    ds_read_b64_tr_b16 a[100:101], v92 offset:8192
    ds_read_b64_tr_b16 a[102:103], v92 offset:10240
    v_mfma_f32_16x16x32_bf16 v[64:67], a[160:163], a[196:199], v[64:67]
    ds_read_b64_tr_b16 a[104:105], v93 offset:8192
    ds_read_b64_tr_b16 a[106:107], v93 offset:10240
    v_mfma_f32_16x16x32_bf16 v[68:71], a[160:163], a[200:203], v[68:71]
    buffer_load_dwordx4 a[140:143], v98, s[80:83], s14 offen offset:768 sc1
    v_mfma_f32_16x16x32_bf16 v[72:75], a[160:163], a[204:207], v[72:75]
    ds_read_b64_tr_b16 a[108:109], v94 offset:8192
    ds_read_b64_tr_b16 a[110:111], v94 offset:10240
    v_mfma_f32_16x16x32_bf16 v[60:63], a[164:167], a[208:211], v[60:63]
    s_waitcnt vmcnt(9) lgkmcnt(15)
    ds_read_b64_tr_b16 a[112:113], v91 offset:12288
    ds_read_b64_tr_b16 a[114:115], v91 offset:14336
    v_mfma_f32_16x16x32_bf16 v[64:67], a[164:167], a[212:215], v[64:67]
    ds_read_b64_tr_b16 a[116:117], v92 offset:12288
    ds_read_b64_tr_b16 a[118:119], v92 offset:14336
    v_mfma_f32_16x16x32_bf16 v[68:71], a[164:167], a[216:219], v[68:71]
    s_addk_i32 s14, 0x2000
    buffer_load_dwordx4 a[144:147], v98, s[80:83], s14 offen offset:0 sc1
    v_mfma_f32_16x16x32_bf16 v[72:75], a[164:167], a[220:223], v[72:75]
    ds_read_b64_tr_b16 a[120:121], v93 offset:12288
    ds_read_b64_tr_b16 a[122:123], v93 offset:14336
    v_mfma_f32_16x16x32_bf16 v[60:63], a[168:171], a[224:227], v[60:63]
    s_waitcnt vmcnt(9)
    ds_read_b64_tr_b16 a[124:125], v94 offset:12288
    ds_read_b64_tr_b16 a[126:127], v94 offset:14336
    v_mfma_f32_16x16x32_bf16 v[64:67], a[168:171], a[228:231], v[64:67]
    ds_read_b64_tr_b16 a[192:193], v91 offset:16384
    ds_read_b64_tr_b16 a[194:195], v91 offset:18432
    v_mfma_f32_16x16x32_bf16 v[68:71], a[168:171], a[232:235], v[68:71]
    buffer_load_dwordx4 a[148:151], v98, s[80:83], s14 offen offset:128 sc1
    v_mfma_f32_16x16x32_bf16 v[72:75], a[168:171], a[236:239], v[72:75]
    ds_read_b64_tr_b16 a[196:197], v92 offset:16384
    ds_read_b64_tr_b16 a[198:199], v92 offset:18432
    v_mfma_f32_16x16x32_bf16 v[60:63], a[172:175], a[240:243], v[60:63]
    s_waitcnt vmcnt(9)
    ds_read_b64_tr_b16 a[200:201], v93 offset:16384
    ds_read_b64_tr_b16 a[202:203], v93 offset:18432
    v_mfma_f32_16x16x32_bf16 v[64:67], a[172:175], a[244:247], v[64:67]
    ds_read_b64_tr_b16 a[204:205], v94 offset:16384
    ds_read_b64_tr_b16 a[206:207], v94 offset:18432
    v_mfma_f32_16x16x32_bf16 v[68:71], a[172:175], a[248:251], v[68:71]
    buffer_load_dwordx4 a[152:155], v98, s[80:83], s14 offen offset:256 sc1
    v_mfma_f32_16x16x32_bf16 v[72:75], a[172:175], a[252:255], v[72:75]
    ds_read_b64_tr_b16 a[208:209], v91 offset:20480
    ds_read_b64_tr_b16 a[210:211], v91 offset:22528
    v_mfma_f32_16x16x32_bf16 v[60:63], a[176:179], a[0:3], v[60:63]
    s_waitcnt vmcnt(9)
    ds_read_b64_tr_b16 a[212:213], v92 offset:20480
    ds_read_b64_tr_b16 a[214:215], v92 offset:22528
    v_mfma_f32_16x16x32_bf16 v[64:67], a[176:179], a[4:7], v[64:67]
    ds_read_b64_tr_b16 a[216:217], v93 offset:20480
    ds_read_b64_tr_b16 a[218:219], v93 offset:22528
    v_mfma_f32_16x16x32_bf16 v[68:71], a[176:179], a[8:11], v[68:71]
    buffer_load_dwordx4 a[156:159], v98, s[80:83], s14 offen offset:512 sc1
    v_mfma_f32_16x16x32_bf16 v[72:75], a[176:179], a[12:15], v[72:75]
    ds_read_b64_tr_b16 a[220:221], v94 offset:20480
    ds_read_b64_tr_b16 a[222:223], v94 offset:22528
    v_mfma_f32_16x16x32_bf16 v[60:63], a[180:183], a[16:19], v[60:63]
    s_waitcnt vmcnt(9)
    ds_read_b64_tr_b16 a[224:225], v91 offset:24576
    ds_read_b64_tr_b16 a[226:227], v91 offset:26624
    v_mfma_f32_16x16x32_bf16 v[64:67], a[180:183], a[20:23], v[64:67]
    ds_read_b64_tr_b16 a[228:229], v92 offset:24576
    ds_read_b64_tr_b16 a[230:231], v92 offset:26624
    v_mfma_f32_16x16x32_bf16 v[68:71], a[180:183], a[24:27], v[68:71]
    buffer_load_dwordx4 a[160:163], v98, s[80:83], s14 offen offset:640 sc1
    v_mfma_f32_16x16x32_bf16 v[72:75], a[180:183], a[28:31], v[72:75]
    ds_read_b64_tr_b16 a[232:233], v93 offset:24576
    ds_read_b64_tr_b16 a[234:235], v93 offset:26624
    v_mfma_f32_16x16x32_bf16 v[60:63], a[184:187], a[32:35], v[60:63]
    s_waitcnt vmcnt(9)
    ds_read_b64_tr_b16 a[236:237], v94 offset:24576
    ds_read_b64_tr_b16 a[238:239], v94 offset:26624
    v_mfma_f32_16x16x32_bf16 v[64:67], a[184:187], a[36:39], v[64:67]
    ds_read_b64_tr_b16 a[240:241], v91 offset:28672
    ds_read_b64_tr_b16 a[242:243], v91 offset:30720
    v_mfma_f32_16x16x32_bf16 v[68:71], a[184:187], a[40:43], v[68:71]
    buffer_load_dwordx4 a[164:167], v98, s[80:83], s14 offen offset:768 sc1
    v_mfma_f32_16x16x32_bf16 v[72:75], a[184:187], a[44:47], v[72:75]
    ds_read_b64_tr_b16 a[244:245], v92 offset:28672
    ds_read_b64_tr_b16 a[246:247], v92 offset:30720
    v_mfma_f32_16x16x32_bf16 v[60:63], a[188:191], a[48:51], v[60:63]
    s_waitcnt vmcnt(9)
    ds_read_b64_tr_b16 a[248:249], v93 offset:28672
    ds_read_b64_tr_b16 a[250:251], v93 offset:30720
    v_mfma_f32_16x16x32_bf16 v[64:67], a[188:191], a[52:55], v[64:67]
    ds_read_b64_tr_b16 a[252:253], v94 offset:28672
    ds_read_b64_tr_b16 a[254:255], v94 offset:30720
    v_mfma_f32_16x16x32_bf16 v[68:71], a[188:191], a[56:59], v[68:71]
    s_addk_i32 s14, 0x2000
    buffer_load_dwordx4 a[168:171], v98, s[80:83], s14 offen offset:0 sc1
    v_mfma_f32_16x16x32_bf16 v[72:75], a[188:191], a[60:63], v[72:75]
    v_add_u32 v91, 0x18000, v91
    v_add_u32 v92, 0x18000, v92
    v_mfma_f32_16x16x32_bf16 v[104:107], a[128:131], a[64:67], 0
    s_waitcnt vmcnt(9) lgkmcnt(15)
    v_add_u32 v93, 0x18000, v93
    v_add_u32 v94, 0x18000, v94
    v_mfma_f32_16x16x32_bf16 v[108:111], a[128:131], a[68:71], 0
    ds_read_b64_tr_b16 a[0:1], v91 offset:0
    ds_read_b64_tr_b16 a[2:3], v91 offset:2048
    v_mfma_f32_16x16x32_bf16 v[112:115], a[128:131], a[72:75], 0
    buffer_load_dwordx4 a[172:175], v98, s[80:83], s14 offen offset:128 sc1
    v_mfma_f32_16x16x32_bf16 v[116:119], a[128:131], a[76:79], 0
    ds_read_b64_tr_b16 a[4:5], v92 offset:0
    ds_read_b64_tr_b16 a[6:7], v92 offset:2048
    v_mfma_f32_16x16x32_bf16 v[104:107], a[132:135], a[80:83], v[104:107]
    s_waitcnt vmcnt(9)
    ds_read_b64_tr_b16 a[8:9], v93 offset:0
    ds_read_b64_tr_b16 a[10:11], v93 offset:2048
    v_mfma_f32_16x16x32_bf16 v[108:111], a[132:135], a[84:87], v[108:111]
    ds_read_b64_tr_b16 a[12:13], v94 offset:0
    ds_read_b64_tr_b16 a[14:15], v94 offset:2048
    v_mfma_f32_16x16x32_bf16 v[112:115], a[132:135], a[88:91], v[112:115]
    buffer_load_dwordx4 a[176:179], v98, s[80:83], s14 offen offset:256 sc1
    v_mfma_f32_16x16x32_bf16 v[116:119], a[132:135], a[92:95], v[116:119]
    ds_read_b64_tr_b16 a[16:17], v91 offset:4096
    ds_read_b64_tr_b16 a[18:19], v91 offset:6144
    v_mfma_f32_16x16x32_bf16 v[104:107], a[136:139], a[96:99], v[104:107]
    s_waitcnt vmcnt(9)
    ds_read_b64_tr_b16 a[20:21], v92 offset:4096
    ds_read_b64_tr_b16 a[22:23], v92 offset:6144
    v_mfma_f32_16x16x32_bf16 v[108:111], a[136:139], a[100:103], v[108:111]
    ds_read_b64_tr_b16 a[24:25], v93 offset:4096
    ds_read_b64_tr_b16 a[26:27], v93 offset:6144
    v_mfma_f32_16x16x32_bf16 v[112:115], a[136:139], a[104:107], v[112:115]
    buffer_load_dwordx4 a[180:183], v98, s[80:83], s14 offen offset:512 sc1
    v_mfma_f32_16x16x32_bf16 v[116:119], a[136:139], a[108:111], v[116:119]
    ds_read_b64_tr_b16 a[28:29], v94 offset:4096
    ds_read_b64_tr_b16 a[30:31], v94 offset:6144
    v_mfma_f32_16x16x32_bf16 v[104:107], a[140:143], a[112:115], v[104:107]
    s_waitcnt vmcnt(9)
    ds_read_b64_tr_b16 a[32:33], v91 offset:8192
    ds_read_b64_tr_b16 a[34:35], v91 offset:10240
    v_mfma_f32_16x16x32_bf16 v[108:111], a[140:143], a[116:119], v[108:111]
    ds_read_b64_tr_b16 a[36:37], v92 offset:8192
    ds_read_b64_tr_b16 a[38:39], v92 offset:10240
    v_mfma_f32_16x16x32_bf16 v[112:115], a[140:143], a[120:123], v[112:115]
    buffer_load_dwordx4 a[184:187], v98, s[80:83], s14 offen offset:640 sc1
    v_mfma_f32_16x16x32_bf16 v[116:119], a[140:143], a[124:127], v[116:119]
    ds_read_b64_tr_b16 a[40:41], v93 offset:8192
    ds_read_b64_tr_b16 a[42:43], v93 offset:10240
    v_mfma_f32_16x16x32_bf16 v[104:107], a[144:147], a[192:195], v[104:107]
    s_waitcnt vmcnt(9)
    ds_read_b64_tr_b16 a[44:45], v94 offset:8192
    ds_read_b64_tr_b16 a[46:47], v94 offset:10240
    v_mfma_f32_16x16x32_bf16 v[108:111], a[144:147], a[196:199], v[108:111]
    ds_read_b64_tr_b16 a[48:49], v91 offset:12288
    ds_read_b64_tr_b16 a[50:51], v91 offset:14336
    v_mfma_f32_16x16x32_bf16 v[112:115], a[144:147], a[200:203], v[112:115]
    buffer_load_dwordx4 a[188:191], v98, s[80:83], s14 offen offset:768 sc1
    v_mfma_f32_16x16x32_bf16 v[116:119], a[144:147], a[204:207], v[116:119]
    ds_read_b64_tr_b16 a[52:53], v92 offset:12288
    ds_read_b64_tr_b16 a[54:55], v92 offset:14336
    v_mfma_f32_16x16x32_bf16 v[104:107], a[148:151], a[208:211], v[104:107]
    s_waitcnt vmcnt(9) lgkmcnt(15)
    ds_read_b64_tr_b16 a[56:57], v93 offset:12288
    v_mfma_f32_16x16x32_bf16 v[108:111], a[148:151], a[212:215], v[108:111]
    ds_read_b64_tr_b16 a[58:59], v93 offset:14336
    ds_read_b64_tr_b16 a[60:61], v94 offset:12288
    v_mfma_f32_16x16x32_bf16 v[112:115], a[148:151], a[216:219], v[112:115]
    ds_read_b64_tr_b16 a[62:63], v94 offset:14336
    v_sub_f32 v120, 1.0, v168
    v_mfma_f32_16x16x32_bf16 v[116:119], a[148:151], a[220:223], v[116:119]
    ds_read_b64_tr_b16 a[64:65], v91 offset:16384
    ds_read_b64_tr_b16 a[66:67], v91 offset:18432
    v_mfma_f32_16x16x32_bf16 v[104:107], a[152:155], a[224:227], v[104:107]
    s_waitcnt vmcnt(8)
    ds_read_b64_tr_b16 a[68:69], v92 offset:16384
    v_mfma_f32_16x16x32_bf16 v[108:111], a[152:155], a[228:231], v[108:111]
    ds_read_b64_tr_b16 a[70:71], v92 offset:18432
    ds_read_b64_tr_b16 a[72:73], v93 offset:16384
    v_mfma_f32_16x16x32_bf16 v[112:115], a[152:155], a[232:235], v[112:115]
    ds_read_b64_tr_b16 a[74:75], v93 offset:18432
    v_sub_f32 v121, 1.0, v169
    v_mfma_f32_16x16x32_bf16 v[116:119], a[152:155], a[236:239], v[116:119]
    ds_read_b64_tr_b16 a[76:77], v94 offset:16384
    ds_read_b64_tr_b16 a[78:79], v94 offset:18432
    v_mfma_f32_16x16x32_bf16 v[104:107], a[156:159], a[240:243], v[104:107]
    s_waitcnt vmcnt(7)
    ds_read_b64_tr_b16 a[80:81], v91 offset:20480
    v_mfma_f32_16x16x32_bf16 v[108:111], a[156:159], a[244:247], v[108:111]
    ds_read_b64_tr_b16 a[82:83], v91 offset:22528
    ds_read_b64_tr_b16 a[84:85], v92 offset:20480
    v_mfma_f32_16x16x32_bf16 v[112:115], a[156:159], a[248:251], v[112:115]
    ds_read_b64_tr_b16 a[86:87], v92 offset:22528
    v_sub_f32 v122, 1.0, v170
    v_mfma_f32_16x16x32_bf16 v[116:119], a[156:159], a[252:255], v[116:119]
    ds_read_b64_tr_b16 a[88:89], v93 offset:20480
    ds_read_b64_tr_b16 a[90:91], v93 offset:22528
    v_mfma_f32_16x16x32_bf16 v[104:107], a[160:163], a[0:3], v[104:107]
    s_waitcnt vmcnt(6) lgkmcnt(15)
    ds_read_b64_tr_b16 a[92:93], v94 offset:20480
    v_mfma_f32_16x16x32_bf16 v[108:111], a[160:163], a[4:7], v[108:111]
    ds_read_b64_tr_b16 a[94:95], v94 offset:22528
    ds_read_b64_tr_b16 a[96:97], v91 offset:24576
    v_mfma_f32_16x16x32_bf16 v[112:115], a[160:163], a[8:11], v[112:115]
    ds_read_b64_tr_b16 a[98:99], v91 offset:26624
    v_sub_f32 v123, 1.0, v171
    v_mfma_f32_16x16x32_bf16 v[116:119], a[160:163], a[12:15], v[116:119]
    ds_read_b64_tr_b16 a[100:101], v92 offset:24576
    ds_read_b64_tr_b16 a[102:103], v92 offset:26624
    v_mfma_f32_16x16x32_bf16 v[104:107], a[164:167], a[16:19], v[104:107]
    s_waitcnt vmcnt(5)
    ds_read_b64_tr_b16 a[104:105], v93 offset:24576
    v_mfma_f32_16x16x32_bf16 v[108:111], a[164:167], a[20:23], v[108:111]
    ds_read_b64_tr_b16 a[106:107], v93 offset:26624
    ds_read_b64_tr_b16 a[108:109], v94 offset:24576
    v_mfma_f32_16x16x32_bf16 v[112:115], a[164:167], a[24:27], v[112:115]
    ds_read_b64_tr_b16 a[110:111], v94 offset:26624
    v_mul_f32 v60, v168, v60
    v_mfma_f32_16x16x32_bf16 v[116:119], a[164:167], a[28:31], v[116:119]
    ds_read_b64_tr_b16 a[112:113], v91 offset:28672
    ds_read_b64_tr_b16 a[114:115], v91 offset:30720
    v_mfma_f32_16x16x32_bf16 v[104:107], a[168:171], a[32:35], v[104:107]
    s_waitcnt vmcnt(4) lgkmcnt(15)
    ds_read_b64_tr_b16 a[116:117], v92 offset:28672
    v_mfma_f32_16x16x32_bf16 v[108:111], a[168:171], a[36:39], v[108:111]
    ds_read_b64_tr_b16 a[118:119], v92 offset:30720
    ds_read_b64_tr_b16 a[120:121], v93 offset:28672
    v_mfma_f32_16x16x32_bf16 v[112:115], a[168:171], a[40:43], v[112:115]
    ds_read_b64_tr_b16 a[122:123], v93 offset:30720
    v_mul_f32 v61, v169, v61
    v_mfma_f32_16x16x32_bf16 v[116:119], a[168:171], a[44:47], v[116:119]
    ds_read_b64_tr_b16 a[124:125], v94 offset:28672
    ds_read_b64_tr_b16 a[126:127], v94 offset:30720
    v_mfma_f32_16x16x32_bf16 v[104:107], a[172:175], a[48:51], v[104:107]
    s_waitcnt vmcnt(3)
    v_mul_f32 v62, v170, v62
    v_mfma_f32_16x16x32_bf16 v[108:111], a[172:175], a[52:55], v[108:111]
    v_mul_f32 v63, v171, v63
    v_mul_f32 v64, v168, v64
    v_mfma_f32_16x16x32_bf16 v[112:115], a[172:175], a[56:59], v[112:115]
    v_mul_f32 v65, v169, v65
    v_mul_f32 v66, v170, v66
    v_mfma_f32_16x16x32_bf16 v[116:119], a[172:175], a[60:63], v[116:119]
    v_mul_f32 v67, v171, v67
    v_mul_f32 v68, v168, v68
    s_mov_b32 s41, 0x8000
    v_mfma_f32_16x16x32_bf16 v[104:107], a[176:179], a[64:67], v[104:107]
    v_mul_f32 v69, v169, v69
    v_mul_f32 v70, v170, v70
    s_waitcnt vmcnt(2)
    v_mfma_f32_16x16x32_bf16 v[104:107], a[180:183], a[80:83], v[104:107]
    v_mul_f32 v71, v171, v71
    v_mul_f32 v72, v168, v72
    s_waitcnt vmcnt(1) lgkmcnt(14)
    v_mfma_f32_16x16x32_bf16 v[104:107], a[184:187], a[96:99], v[104:107]
    v_mul_f32 v73, v169, v73
    v_mul_f32 v74, v170, v74
    s_waitcnt vmcnt(0) lgkmcnt(6)
    v_mfma_f32_16x16x32_bf16 v[104:107], a[188:191], a[112:115], v[104:107]
    v_mul_f32 v75, v171, v75
    v_mfma_f32_16x16x32_bf16 v[108:111], a[176:179], a[68:71], v[108:111]
    v_mfma_f32_16x16x32_bf16 v[108:111], a[180:183], a[84:87], v[108:111]
    v_mfma_f32_16x16x32_bf16 v[108:111], a[184:187], a[100:103], v[108:111]
    s_nop 3
    v_fmac_f32 v60, v104, v120
    v_fmac_f32 v61, v105, v121
    s_waitcnt lgkmcnt(4)
    v_mfma_f32_16x16x32_bf16 v[108:111], a[188:191], a[116:119], v[108:111]
    v_fmac_f32 v62, v106, v122
    v_fmac_f32 v63, v107, v123
    v_mfma_f32_16x16x32_bf16 v[112:115], a[176:179], a[72:75], v[112:115]
    buffer_store_dword v60, v50, s[84:87], 0 offen offset:0 nt
    buffer_store_dword v61, v50, s[84:87], s41 offen offset:0 nt
    v_mfma_f32_16x16x32_bf16 v[112:115], a[180:183], a[88:91], v[112:115]
    buffer_store_dword v62, v50, s[84:87], 0 offen offset:2048 nt
    buffer_store_dword v63, v50, s[84:87], s41 offen offset:2048 nt
    v_mfma_f32_16x16x32_bf16 v[112:115], a[184:187], a[104:107], v[112:115]
    v_fmac_f32 v64, v108, v120
    v_fmac_f32 v65, v109, v121
    s_waitcnt lgkmcnt(2)
    v_mfma_f32_16x16x32_bf16 v[112:115], a[188:191], a[120:123], v[112:115]
    v_fmac_f32 v66, v110, v122
    v_fmac_f32 v67, v111, v123
    v_mfma_f32_16x16x32_bf16 v[116:119], a[176:179], a[76:79], v[116:119]
    buffer_store_dword v64, v50, s[84:87], 0 offen offset:64 nt
    buffer_store_dword v65, v50, s[84:87], s41 offen offset:64 nt
    v_mfma_f32_16x16x32_bf16 v[116:119], a[180:183], a[92:95], v[116:119]
    buffer_store_dword v66, v50, s[84:87], 0 offen offset:2112 nt
    buffer_store_dword v67, v50, s[84:87], s41 offen offset:2112 nt
    v_mfma_f32_16x16x32_bf16 v[116:119], a[184:187], a[108:111], v[116:119]
    v_fmac_f32 v68, v112, v120
    v_fmac_f32 v69, v113, v121
    s_waitcnt lgkmcnt(0)
    v_mfma_f32_16x16x32_bf16 v[116:119], a[188:191], a[124:127], v[116:119]
    v_fmac_f32 v70, v114, v122
    v_fmac_f32 v71, v115, v123
    buffer_store_dword v68, v50, s[84:87], 0 offen offset:128 nt
    buffer_store_dword v69, v50, s[84:87], s41 offen offset:128 nt
    buffer_store_dword v70, v50, s[84:87], 0 offen offset:2176 nt
    buffer_store_dword v71, v50, s[84:87], s41 offen offset:2176 nt
    s_nop 1
    v_fmac_f32 v72, v116, v120
    v_fmac_f32 v73, v117, v121
    v_fmac_f32 v74, v118, v122
    v_fmac_f32 v75, v119, v123
    buffer_store_dword v72, v50, s[84:87], 0 offen offset:192 nt
    buffer_store_dword v73, v50, s[84:87], s41 offen offset:192 nt
    buffer_store_dword v74, v50, s[84:87], 0 offen offset:2240 nt
    buffer_store_dword v75, v50, s[84:87], s41 offen offset:2240 nt
    s_cmp_lg_u32 s2, 0xff
    s_cbranch_scc1 L_end
    s_cmp_lg_u32 s3, 0
    s_cbranch_scc1 L_end
    v_mov_b32 v4, 0
    v_mov_b32 v5, s43
    s_mov_b64 exec, 1
    buffer_store_dword v5, v4, s[80:83], 0 offen sc1
    s_endpgm
L_end:
    s_endpgm
.section .rodata,"a"
.p2align 6
.amdhsa_kernel gated_mix__ssm_conv_s5__linear_attn_block__prompt_kernel
  .amdhsa_next_free_vgpr 512
  .amdhsa_next_free_sgpr 102
  .amdhsa_accum_offset 256
  .amdhsa_group_segment_fixed_size 0
  .amdhsa_kernarg_size 128
  .amdhsa_user_sgpr_count 2
  .amdhsa_user_sgpr_kernarg_segment_ptr 1
  .amdhsa_system_sgpr_workgroup_id_x 1
.end_amdhsa_kernel
```
